```python
import torch

def _softmax(x, axis=-1):
    return torch.softmax(x, dim=axis)
def _gelu(x):
    return torch.nn.functional.gelu(x, approximate="tanh")
def _silu(x):
    return torch.nn.functional.silu(x)
def _sigmoid(x):
    return torch.sigmoid(x)
def _layernorm(x, axis=-1, eps=1e-5):
    m = x.mean(dim=axis, keepdim=True)
    v = x.var(dim=axis, keepdim=True, unbiased=False)
    return (x - m) / torch.sqrt(v + eps)
def _scatter_add(tgt, idx, src, axis=0):
    return tgt.clone().index_add_(axis, idx, src)
def _segment_sum(src, seg, n):
    out = torch.zeros((n,) + src.shape[1:], dtype=src.dtype)
    return out.index_add_(0, seg, src)
def _pad(x, pw):
    flat = tuple(v for pair in reversed(pw) for v in pair)
    return torch.nn.functional.pad(x, flat)

kernel_name = 'recurrent_scan__ssm_conv_s5__mixer_channel_mlp__prompt'

def setup_inputs():

    _w = (lambda a: (lambda t: t.to(torch.bfloat16) if t.is_floating_point() else t)(torch.as_tensor(a)))
    def _A_setup():
        B, S, D = 1, 2048, 448
        P = D
        Lambda_re = -0.5 * (lambda _x: torch.exp(torch.as_tensor(_x)))((lambda *s: torch.randn(*s, dtype=torch.bfloat16) * 0.4)(P))
        Lambda_im = (lambda *s: torch.randn(*s, dtype=torch.bfloat16) * 0.4)(P) * 1.0
        B_re = (lambda *s: torch.randn(*s, dtype=torch.bfloat16) * 0.4)(P, D) * (D ** -0.5)
        B_im = (lambda *s: torch.randn(*s, dtype=torch.bfloat16) * 0.4)(P, D) * (D ** -0.5)
        C_re = (lambda *s: torch.randn(*s, dtype=torch.bfloat16) * 0.4)(D, P) * (P ** -0.5)
        C_im = (lambda *s: torch.randn(*s, dtype=torch.bfloat16) * 0.4)(D, P) * (P ** -0.5)
        log_dt = (lambda *s: torch.randn(*s, dtype=torch.bfloat16) * 0.4)(P) * 0.3 - 2.0
        Dskip = (lambda *s: torch.randn(*s, dtype=torch.bfloat16) * 0.2)(D)
        return {
            "x": _w((lambda *s: torch.randn(*s, dtype=torch.bfloat16) * 0.05)(B, S, D)),
            "Lambda_re": _w(Lambda_re),
            "Lambda_im": _w(Lambda_im),
            "B_re": _w(B_re),
            "B_im": _w(B_im),
            "C_re": _w(C_re),
            "C_im": _w(C_im),
            "log_dt": _w(log_dt),
            "Dskip": _w(Dskip),
        }
    _A_in = _A_setup()

    def _B_setup():
        B, S, D, F = 1, 2048, 448, 1792
        return {
            "x": _w((lambda *s: torch.randn(*s, dtype=torch.bfloat16) * 0.05)(B, S, D)),
            "w1": _w((lambda *s: torch.randn(*s, dtype=torch.bfloat16) * 0.8)(D, F) * (D ** -0.5)),
            "b1": _w((lambda *s: torch.randn(*s, dtype=torch.bfloat16) * 0.4)(F)),
            "w2": _w((lambda *s: torch.randn(*s, dtype=torch.bfloat16) * 0.1)(F, D) * (F ** -0.5)),
            "b2": _w((lambda *s: torch.randn(*s, dtype=torch.bfloat16) * 0.1)(D)),
        }
    _B_in = _B_setup()

    return {
        "A_x": _A_in["x"],
        "A_Lambda_re": _A_in["Lambda_re"],
        "A_Lambda_im": _A_in["Lambda_im"],
        "A_B_re": _A_in["B_re"],
        "A_B_im": _A_in["B_im"],
        "A_C_re": _A_in["C_re"],
        "A_C_im": _A_in["C_im"],
        "A_log_dt": _A_in["log_dt"],
        "A_Dskip": _A_in["Dskip"],
        "B_x": _B_in["x"],
        "B_w1": _B_in["w1"],
        "B_b1": _B_in["b1"],
        "B_w2": _B_in["w2"],
        "B_b2": _B_in["b2"],
    }

def reference(A_x, A_Lambda_re, A_Lambda_im, A_B_re, A_B_im, A_C_re, A_C_im, A_log_dt, A_Dskip, B_x, B_w1, B_b1, B_w2, B_b2):
    def _A_ref(x, Lambda_re, Lambda_im, B_re, B_im, C_re, C_im, log_dt, Dskip):
        Bsz, L, H = x.shape
        Lam = Lambda_re + 1j * Lambda_im
        Bmat = B_re + 1j * B_im
        Cmat = C_re + 1j * C_im
        dt = torch.exp(log_dt)
        Lam_bar = torch.exp(dt * Lam)
        B_bar = ((Lam_bar - 1.0) / Lam)[:, None] * Bmat
        Bu = torch.einsum("bld,pd->blp", x + 0j, B_bar)
        h = torch.zeros_like(Bu[:, 0, :])
        hs = []
        for t in range(L):
            h = Lam_bar[None, :] * h + Bu[:, t, :]
            hs.append(h)
        hseq = torch.stack(hs, 1)
        y = 2.0 * torch.einsum("blp,dp->bld", hseq, Cmat).real + x * Dskip[None, None, :]
        return y

    def _B_ref(x, w1, b1, w2, b2):
        y = _layernorm(x, axis=-1)
        h = _gelu(torch.einsum("bsd,df->bsf", y, w1) + b1)
        return torch.einsum("bsf,fd->bsd", h, w2) + b2

    x = A_x
    xn = _layernorm(x, axis=-1)
    s = _A_ref(xn, A_Lambda_re, A_Lambda_im, A_B_re, A_B_im, A_C_re, A_C_im, A_log_dt, A_Dskip)
    g = _silu(_B_ref(xn, B_w1, B_b1, B_w2, B_b2))
    return x + s * g
```

```asm
; @launch grid=(256,1,1) block=(256,1,1) lds=163840
.amdgcn_target "amdgcn-amd-amdhsa--gfx950"
.text
.globl recurrent_scan__ssm_conv_s5__mixer_channel_mlp__prompt_kernel
.p2align 8
.type recurrent_scan__ssm_conv_s5__mixer_channel_mlp__prompt_kernel,@function
recurrent_scan__ssm_conv_s5__mixer_channel_mlp__prompt_kernel:
    s_cmp_ge_u32 s2, 256
    s_cbranch_scc1 L_exit
    s_load_dwordx16 s[44:59], s[0:1], 0
    s_load_dwordx16 s[60:75], s[0:1], 64
    s_load_dwordx2 s[76:77], s[0:1], 128
    v_lshrrev_b32 v2, 6, v0
    v_and_b32 v1, 63, v0
    v_readfirstlane_b32 s3, v2
    v_and_b32 v2, 31, v1
    v_lshrrev_b32 v3, 5, v1
    s_getpc_b64 s[78:79]
L_pc:
    s_lshr_b32 s80, s2, 3
    s_mul_i32 s80, s80, 896
    v_min_u32 v4, 6, v1
    v_lshlrev_b32 v4, 7, v4
    v_add_u32 v4, s80, v4
    v_min_u32 v4, L_endcode-L_pc-4, v4
    global_load_dword v5, v4, s[78:79]
    s_cmp_ge_u32 s2, 224
    s_cbranch_scc1 L_spare
    s_and_b32 s80, s2, 7
    s_lshr_b32 s81, s2, 3
    s_mul_i32 s82, s81, 37
    s_lshr_b32 s82, s82, 8
    s_mul_i32 s83, s82, 7
    s_sub_u32 s83, s81, s83
    s_lshr_b32 s84, s80, 1
    s_lshl_b32 s84, s84, 2
    s_add_u32 s4, s84, s82
    s_and_b32 s84, s80, 1
    s_mul_i32 s84, s84, 7
    s_add_u32 s5, s84, s83
    s_lshl_b32 s84, s80, 2
    s_add_u32 s6, s84, s82
    s_mov_b32 s7, s83
    s_lshl_b32 s84, s82, 1
    s_add_u32 s8, s83, s84
    s_cmp_ge_u32 s8, 7
    s_cselect_b32 s84, 7, 0
    s_sub_u32 s8, s8, s84
    s_cmp_ge_u32 s8, 7
    s_cselect_b32 s84, 7, 0
    s_sub_u32 s8, s8, s84
    s_mov_b32 s9, s82
    v_lshrrev_b32 v255, 3, v1
    v_lshrrev_b32 v254, 4, v1
    v_and_b32 v253, 7, v1
    s_lshl_b32 s84, s3, 5
    s_movk_i32 s85, 896
    v_add_u32 v252, s84, v255
    v_mul_u32_u24 v252, s85, v252
    v_xor_b32 v251, v253, v254
    v_lshl_add_u32 v249, v251, 4, v252
    v_xor_b32 v251, 4, v251
    v_lshl_add_u32 v248, v251, 4, v252
    v_add_u32 v248, 6144, v248
    v_add_u32 v247, 12288, v249
    v_add_u32 v246, 12288, v248
    s_lshl_b32 s84, s3, 3
    v_add_u32 v252, s84, v255
    v_mul_u32_u24 v252, s85, v252
    s_and_b32 s84, s3, 1
    s_lshl_b32 s84, s84, 2
    v_xor_b32 v251, v253, v254
    v_xor_b32 v251, s84, v251
    v_lshl_add_u32 v245, v251, 4, v252
    s_movk_i32 s85, 3584
    v_and_b32 v252, 15, v1
    v_lshlrev_b32 v251, 2, v254
    v_xor_b32 v252, v252, v251
    v_mul_u32_u24 v251, s85, v254
    v_lshl_add_u32 v244, v252, 4, v251
    v_add_u32 v243, 13312, v244
    v_add_u32 v242, 26624, v244
    v_add_u32 v241, 39936, v244
    s_mul_i32 s86, s4, 114688
    s_mul_i32 s87, s5, 28672
    s_mul_i32 s88, s3, 57344
    s_lshl_b32 s84, s5, 8
    s_add_u32 s88, s88, s84
    s_lshl_b32 s89, s3, 12
    s_lshl_b32 s90, s3, 11
    s_mov_b32 s91, s8
    s_waitcnt lgkmcnt(0)
    s_mov_b32 s84, 11386880
    s_load_dword s96, s[76:77], s84
    s_mov_b32 s12, s44
    s_and_b32 s13, s45, 0xffff
    s_mov_b32 s14, 1835008
    s_mov_b32 s15, 0x20000
    s_mov_b32 s16, s50
    s_and_b32 s17, s51, 0xffff
    s_mov_b32 s18, 401408
    s_mov_b32 s19, 0x20000
    s_sub_u32 s20, s52, 1024
    s_subb_u32 s21, s53, 0
    s_and_b32 s21, s21, 0xffff
    s_mov_b32 s22, 402432
    s_mov_b32 s23, 0x20000
    s_mov_b32 s24, s64
    s_and_b32 s25, s65, 0xffff
    s_mov_b32 s26, 1605632
    s_mov_b32 s27, 0x20000
    s_lshl_b32 s78, s91, 7
    s_add_u32 s92, s86, s78
    s_add_u32 s93, s87, s78
    s_mul_i32 s78, s91, 229376
    s_add_u32 s94, s88, s78
    s_add_u32 s91, s91, 1
    s_cmp_eq_u32 s91, 7
    s_cselect_b32 s91, 0, s91
    s_add_u32 m0, s89, 0
    s_nop 0
    buffer_load_dwordx4 v249, s[12:15], s92 offen offset:0 lds
    buffer_load_dwordx4 v248, s[12:15], s92 offen offset:1024 lds
    buffer_load_dwordx4 v247, s[12:15], s92 offen offset:2048 lds
    buffer_load_dwordx4 v246, s[12:15], s92 offen offset:3072 lds
    s_add_u32 m0, s90, 49152
    s_nop 0
    buffer_load_dwordx4 v245, s[16:19], s93 offen lds
    buffer_load_dwordx4 v245, s[20:23], s93 offen offset:1024 lds
    s_add_u32 m0, s89, 73728
    s_nop 0
    buffer_load_dwordx4 v244, s[24:27], s94 offen offset:0 lds
    buffer_load_dwordx4 v243, s[24:27], s94 offen offset:1024 lds
    buffer_load_dwordx4 v242, s[24:27], s94 offen offset:2048 lds
    buffer_load_dwordx4 v241, s[24:27], s94 offen offset:3072 lds
    v_and_b32 v251, 0x13, v2
    v_bfe_u32 v250, v2, 2, 1
    v_lshl_add_u32 v251, v250, 3, v251
    v_bfe_u32 v250, v2, 3, 1
    v_lshl_add_u32 v240, v250, 2, v251
    s_lshl_b32 s84, s5, 5
    v_add_lshl_u32 v240, v240, s84, 1
    global_load_ushort v255, v240, s[46:47]
    global_load_ushort v254, v240, s[48:49]
    global_load_ushort v253, v240, s[58:59]
    v_and_b32 v251, 127, v0
    s_lshl_b32 s84, s5, 7
    v_add_lshl_u32 v251, v251, s84, 1
    global_load_ushort v252, v251, s[66:67]
    s_lshl_b32 s84, s7, 6
    v_add_lshl_u32 v251, v1, s84, 1
    global_load_ushort v239, v251, s[60:61]
    global_load_ushort v238, v251, s[70:71]
    s_mov_b32 s28, s76
    s_and_b32 s29, s77, 0xffff
    s_mov_b32 s30, 33554432
    s_mov_b32 s31, 0x20000
    s_mov_b32 s36, s68
    s_and_b32 s37, s69, 0xffff
    s_mov_b32 s38, 1605632
    s_mov_b32 s39, 0x20000
    s_mov_b64 s[76:77], s[72:73]
    s_cmp_ge_u32 s3, 2
    s_cselect_b32 s32, s56, s54
    s_cselect_b32 s33, s57, s55
    s_and_b32 s33, s33, 0xffff
    s_mov_b32 s34, 401408
    s_mov_b32 s35, 0x20000
    v_bfe_u32 v251, v2, 2, 1
    v_lshlrev_b32 v251, 4, v251
    v_lshrrev_b32 v250, 3, v2
    v_lshl_add_u32 v251, v250, 2, v251
    v_and_b32 v250, 3, v2
    v_add_u32 v232, v251, v250
    v_and_b32 v251, 0x13, v2
    v_bfe_u32 v250, v2, 2, 1
    v_lshl_add_u32 v251, v250, 3, v251
    v_bfe_u32 v250, v2, 3, 1
    v_lshl_add_u32 v231, v250, 2, v251
    s_lshl_b32 s84, s3, 5
    v_add_u32 v251, s84, v232
    v_lshlrev_b32 v251, 7, v251
    v_bfe_u32 v250, v232, 1, 3
    v_xor_b32 v250, v250, v3
    v_lshrrev_b32 v240, 3, v231
    v_lshlrev_b32 v240, 11, v240
    v_and_b32 v237, 7, v231
    s_lshl_b32 s78, s91, 7
    s_add_u32 s92, s86, s78
    s_add_u32 s93, s87, s78
    s_mul_i32 s78, s91, 229376
    s_add_u32 s94, s88, s78
    s_add_u32 s91, s91, 1
    s_cmp_eq_u32 s91, 7
    s_cselect_b32 s91, 0, s91
    v_lshl_add_u32 v240, v237, 7, v240
    v_add_u32 v240, 49152, v240
    v_bfe_u32 v237, v231, 1, 3
    v_xor_b32 v237, v237, v3
    v_bfe_u32 v236, v1, 2, 2
    v_lshl_add_u32 v235, v3, 3, v236
    v_lshlrev_b32 v235, 8, v235
    s_add_u32 m0, s89, 16384
    s_nop 0
    buffer_load_dwordx4 v249, s[12:15], s92 offen offset:0 lds
    v_bfe_u32 v234, v1, 4, 1
    v_lshlrev_b32 v234, 1, v234
    v_and_b32 v233, 1, v1
    v_add_u32 v234, v234, v233
    v_lshl_add_u32 v235, v234, 4, v235
    v_bfe_u32 v233, v1, 1, 1
    v_lshl_add_u32 v235, v233, 3, v235
    buffer_load_dwordx4 v248, s[12:15], s92 offen offset:1024 lds
    v_xor_b32 v234, 0, v236
    v_lshl_add_u32 v206, v234, 6, v235
    v_xor_b32 v234, 1, v236
    v_lshl_add_u32 v205, v234, 6, v235
    v_xor_b32 v234, 2, v236
    v_lshl_add_u32 v204, v234, 6, v235
    v_xor_b32 v234, 3, v236
    buffer_load_dwordx4 v247, s[12:15], s92 offen offset:2048 lds
    v_lshl_add_u32 v203, v234, 6, v235
    s_add_u32 s84, s3, 0
    s_and_b32 s84, s84, 3
    s_lshl_b32 s85, s84, 1
    v_xor_b32 v234, s85, v250
    v_lshl_add_u32 v230, v234, 4, v251
    v_xor_b32 v234, s85, v237
    v_lshl_add_u32 v226, v234, 4, v240
    s_lshl_b32 s85, s84, 12
    s_add_u32 s85, s85, 73728
    v_add_u32 v222, s85, v206
    v_add_u32 v218, s85, v205
    buffer_load_dwordx4 v246, s[12:15], s92 offen offset:3072 lds
    v_add_u32 v214, s85, v204
    v_add_u32 v210, s85, v203
    s_add_u32 s84, s3, 1
    s_and_b32 s84, s84, 3
    s_lshl_b32 s85, s84, 1
    v_xor_b32 v234, s85, v250
    v_lshl_add_u32 v229, v234, 4, v251
    v_xor_b32 v234, s85, v237
    v_lshl_add_u32 v225, v234, 4, v240
    s_lshl_b32 s85, s84, 12
    s_add_u32 s85, s85, 73728
    v_add_u32 v221, s85, v206
    s_add_u32 m0, s90, 57344
    s_nop 0
    buffer_load_dwordx4 v245, s[16:19], s93 offen lds
    v_add_u32 v217, s85, v205
    v_add_u32 v213, s85, v204
    v_add_u32 v209, s85, v203
    s_add_u32 s84, s3, 2
    s_and_b32 s84, s84, 3
    s_lshl_b32 s85, s84, 1
    v_xor_b32 v234, s85, v250
    v_lshl_add_u32 v228, v234, 4, v251
    v_xor_b32 v234, s85, v237
    v_lshl_add_u32 v224, v234, 4, v240
    buffer_load_dwordx4 v245, s[20:23], s93 offen offset:1024 lds
    s_lshl_b32 s85, s84, 12
    s_add_u32 s85, s85, 73728
    v_add_u32 v220, s85, v206
    v_add_u32 v216, s85, v205
    v_add_u32 v212, s85, v204
    v_add_u32 v208, s85, v203
    s_add_u32 s84, s3, 3
    s_and_b32 s84, s84, 3
    s_lshl_b32 s85, s84, 1
    v_xor_b32 v234, s85, v250
    v_lshl_add_u32 v227, v234, 4, v251
    v_xor_b32 v234, s85, v237
    s_add_u32 m0, s89, 90112
    s_nop 0
    buffer_load_dwordx4 v244, s[24:27], s94 offen offset:0 lds
    v_lshl_add_u32 v223, v234, 4, v240
    s_lshl_b32 s85, s84, 12
    s_add_u32 s85, s85, 73728
    v_add_u32 v219, s85, v206
    v_add_u32 v215, s85, v205
    v_add_u32 v211, s85, v204
    v_add_u32 v207, s85, v203
    s_and_b32 s84, s9, 1
    s_mul_i32 s84, s84, 3
    s_add_u32 s84, s84, s3
    s_lshl_b32 s84, s84, 7
    s_mul_i32 s85, s7, 57344
    s_add_u32 s84, s84, s85
    s_movk_i32 s85, 896
    v_mul_u32_u24 v251, s85, v1
    v_add_u32 v251, s84, v251
    s_and_b32 s84, s2, 7
    s_mul_i32 s84, s84, 7
    s_lshr_b32 s84, s84, 2
    s_lshl_b32 s85, s3, 1
    s_add_u32 s84, s84, s85
    s_add_u32 s84, s84, 7
    v_add_u32 v240, s84, v3
    s_and_b32 s85, s2, 7
    s_mul_i32 s85, s85, 7
    s_lshr_b32 s85, s85, 2
    s_add_u32 s85, s85, 13
    v_min_u32 v240, s85, v240
    v_subrev_u32 v237, 14, v240
    v_min_u32 v240, v240, v237
    v_lshl_add_u32 v240, v240, 5, v2
    s_movk_i32 s85, 896
    v_mul_u32_u24 v240, s85, v240
    s_mul_i32 s84, s9, 401408
    s_lshl_b32 s85, s7, 7
    s_add_u32 s84, s84, s85
    v_add_u32 v250, s84, v240
    s_cmp_ge_u32 s9, 2
    s_cselect_b32 s40, s56, s54
    s_cselect_b32 s41, s57, s55
    s_and_b32 s41, s41, 0xffff
    s_mov_b32 s42, 401408
    s_mov_b32 s43, 0x20000
    v_mov_b32 v240, 0
    v_mov_b32 v237, 0
    v_mov_b32 v236, 0
    v_mov_b32 v235, 0
    v_mov_b32 v234, 0
    v_mov_b32 v233, 0
    s_mov_b32 s95, 0x3f803f80
    v_lshlrev_b32 v200, 4, v232
    s_lshl_b32 s79, s4, 7
    s_lshl_b32 s84, s3, 5
    s_add_u32 s79, s79, s84
    s_lshl_b32 s79, s79, 4
    s_add_u32 s79, s79, 11010048
    s_mov_b32 s85, 157184
    v_and_b32 v187, 127, v0
    v_lshl_add_u32 v187, v187, 2, s85
    s_waitcnt vmcnt(9)
    v_lshlrev_b32 v252, 16, v252
    ds_write_b32 v187, v252 offset:6144
    s_mov_b32 s85, 155648
    v_lshl_add_u32 v187, v1, 2, s85
    s_waitcnt vmcnt(8)
    v_lshlrev_b32 v239, 16, v239
    s_waitcnt vmcnt(7)
    v_lshlrev_b32 v238, 16, v238
    ds_write_b32 v187, v239
    ds_write_b32 v187, v238 offset:256
    buffer_load_dwordx4 v243, s[24:27], s94 offen offset:1024 lds
    buffer_load_dwordx4 v242, s[24:27], s94 offen offset:2048 lds
    buffer_load_dwordx4 v241, s[24:27], s94 offen offset:3072 lds
    s_waitcnt lgkmcnt(0)
    s_barrier
    ds_read_b128 v[100:103], v230 offset:0
    ds_read_b128 v[104:107], v226 offset:0
    ds_read_b128 v[108:111], v226 offset:1024
    ds_read_b64_tr_b16 v[112:113], v222 offset:0
    ds_read_b64_tr_b16 v[114:115], v222 offset:1024
    ds_read_b64_tr_b16 v[116:117], v218 offset:0
    ds_read_b64_tr_b16 v[118:119], v218 offset:1024
    ds_read_b64_tr_b16 v[120:121], v214 offset:0
    ds_read_b64_tr_b16 v[122:123], v214 offset:1024
    ds_read_b64_tr_b16 v[124:125], v210 offset:0
    ds_read_b64_tr_b16 v[126:127], v210 offset:1024
    s_waitcnt lgkmcnt(0)
    v_mfma_f32_32x32x16_bf16 v[4:19], v[100:103], v[104:107], 0
    ds_read_b128 v[128:131], v229 offset:0
    ds_read_b128 v[132:135], v225 offset:0
    ds_read_b128 v[136:139], v225 offset:1024
    v_mfma_f32_32x32x16_bf16 v[20:35], v[100:103], v[108:111], 0
    ds_read_b64_tr_b16 v[140:141], v221 offset:0
    ds_read_b64_tr_b16 v[142:143], v221 offset:1024
    ds_read_b64_tr_b16 v[144:145], v217 offset:0
    v_mfma_f32_32x32x16_bf16 v[36:51], v[112:115], v[100:103], 0
    ds_read_b64_tr_b16 v[146:147], v217 offset:1024
    ds_read_b64_tr_b16 v[148:149], v213 offset:0
    ds_read_b64_tr_b16 v[150:151], v213 offset:1024
    s_lshl_b32 s78, s91, 7
    s_add_u32 s92, s86, s78
    s_add_u32 s93, s87, s78
    s_mul_i32 s78, s91, 229376
    s_add_u32 s94, s88, s78
    s_add_u32 s91, s91, 1
    s_cmp_eq_u32 s91, 7
    s_cselect_b32 s91, 0, s91
    s_add_u32 m0, s89, 32768
    s_nop 0
    buffer_load_dwordx4 v249, s[12:15], s92 offen offset:0 lds
    v_mfma_f32_32x32x16_bf16 v[52:67], v[116:119], v[100:103], 0
    ds_read_b64_tr_b16 v[152:153], v209 offset:0
    ds_read_b64_tr_b16 v[154:155], v209 offset:1024
    buffer_load_dwordx4 v248, s[12:15], s92 offen offset:1024 lds
    v_mfma_f32_32x32x16_bf16 v[68:83], v[120:123], v[100:103], 0
    buffer_load_dwordx4 v247, s[12:15], s92 offen offset:2048 lds
    v_mfma_f32_32x32x16_bf16 v[84:99], v[124:127], v[100:103], 0
    buffer_load_dwordx4 v246, s[12:15], s92 offen offset:3072 lds
    v_dot2c_f32_bf16 v240, s95, v104
    v_dot2c_f32_bf16 v237, s95, v108
    v_dot2c_f32_bf16 v236, s95, v112
    v_dot2c_f32_bf16 v235, s95, v116
    v_dot2c_f32_bf16 v234, s95, v120
    v_dot2c_f32_bf16 v233, s95, v124
    v_dot2c_f32_bf16 v240, s95, v105
    v_dot2c_f32_bf16 v237, s95, v109
    v_dot2c_f32_bf16 v236, s95, v113
    v_dot2c_f32_bf16 v235, s95, v117
    v_dot2c_f32_bf16 v234, s95, v121
    v_dot2c_f32_bf16 v233, s95, v125
    v_dot2c_f32_bf16 v240, s95, v106
    v_dot2c_f32_bf16 v237, s95, v110
    v_dot2c_f32_bf16 v236, s95, v114
    v_dot2c_f32_bf16 v235, s95, v118
    v_dot2c_f32_bf16 v234, s95, v122
    v_dot2c_f32_bf16 v233, s95, v126
    v_dot2c_f32_bf16 v240, s95, v107
    v_dot2c_f32_bf16 v237, s95, v111
    v_dot2c_f32_bf16 v236, s95, v115
    v_dot2c_f32_bf16 v235, s95, v119
    v_dot2c_f32_bf16 v234, s95, v123
    v_dot2c_f32_bf16 v233, s95, v127
    s_waitcnt lgkmcnt(0)
    v_mfma_f32_32x32x16_bf16 v[4:19], v[128:131], v[132:135], v[4:19]
    ds_read_b128 v[100:103], v228 offset:0
    ds_read_b128 v[104:107], v224 offset:0
    ds_read_b128 v[108:111], v224 offset:1024
    v_mfma_f32_32x32x16_bf16 v[20:35], v[128:131], v[136:139], v[20:35]
    ds_read_b64_tr_b16 v[112:113], v220 offset:0
    ds_read_b64_tr_b16 v[114:115], v220 offset:1024
    ds_read_b64_tr_b16 v[116:117], v216 offset:0
    v_mfma_f32_32x32x16_bf16 v[36:51], v[140:143], v[128:131], v[36:51]
    ds_read_b64_tr_b16 v[118:119], v216 offset:1024
    ds_read_b64_tr_b16 v[120:121], v212 offset:0
    ds_read_b64_tr_b16 v[122:123], v212 offset:1024
    s_add_u32 m0, s90, 65536
    v_lshlrev_b32 v255, 16, v255
    buffer_load_dwordx4 v245, s[16:19], s93 offen lds
    v_lshlrev_b32 v254, 16, v254
    v_mfma_f32_32x32x16_bf16 v[52:67], v[144:147], v[128:131], v[52:67]
    ds_read_b64_tr_b16 v[124:125], v208 offset:0
    ds_read_b64_tr_b16 v[126:127], v208 offset:1024
    v_lshlrev_b32 v253, 16, v253
    v_mfma_f32_32x32x16_bf16 v[68:83], v[148:151], v[128:131], v[68:83]
    buffer_load_dwordx4 v245, s[20:23], s93 offen offset:1024 lds
    v_mul_f32 v206, 0x3fb8aa3b, v253
    v_exp_f32 v206, v206
    v_mfma_f32_32x32x16_bf16 v[84:99], v[152:155], v[128:131], v[84:99]
    v_cvt_pk_bf16_f32 v206, v206, v206
    s_waitcnt lgkmcnt(0)
    v_mfma_f32_32x32x16_bf16 v[4:19], v[100:103], v[104:107], v[4:19]
    ds_read_b128 v[128:131], v227 offset:0
    ds_read_b128 v[132:135], v223 offset:0
    ds_read_b128 v[136:139], v223 offset:1024
    v_mfma_f32_32x32x16_bf16 v[20:35], v[100:103], v[108:111], v[20:35]
    ds_read_b64_tr_b16 v[140:141], v219 offset:0
    ds_read_b64_tr_b16 v[142:143], v219 offset:1024
    ds_read_b64_tr_b16 v[144:145], v215 offset:0
    v_mfma_f32_32x32x16_bf16 v[36:51], v[112:115], v[100:103], v[36:51]
    ds_read_b64_tr_b16 v[146:147], v215 offset:1024
    ds_read_b64_tr_b16 v[148:149], v211 offset:0
    ds_read_b64_tr_b16 v[150:151], v211 offset:1024
    s_add_u32 m0, s89, 106496
    v_lshlrev_b32 v206, 16, v206
    buffer_load_dwordx4 v244, s[24:27], s94 offen offset:0 lds
    v_mul_f32 v202, v206, v255
    v_mfma_f32_32x32x16_bf16 v[52:67], v[116:119], v[100:103], v[52:67]
    ds_read_b64_tr_b16 v[152:153], v207 offset:0
    ds_read_b64_tr_b16 v[154:155], v207 offset:1024
    buffer_load_dwordx4 v243, s[24:27], s94 offen offset:1024 lds
    v_mul_f32 v201, v206, v254
    v_mfma_f32_32x32x16_bf16 v[68:83], v[120:123], v[100:103], v[68:83]
    buffer_load_dwordx4 v242, s[24:27], s94 offen offset:2048 lds
    v_mul_f32 v202, 0x3fb8aa3b, v202
    v_mul_f32 v201, 0xbe22f983, v201
    v_mfma_f32_32x32x16_bf16 v[84:99], v[124:127], v[100:103], v[84:99]
    buffer_load_dwordx4 v241, s[24:27], s94 offen offset:3072 lds
    v_exp_f32 v206, v202
    s_waitcnt lgkmcnt(0)
    s_waitcnt vmcnt(10)
    s_barrier
    v_mfma_f32_32x32x16_bf16 v[4:19], v[128:131], v[132:135], v[4:19]
    ds_read_b128 v[100:103], v230 offset:16384
    ds_read_b128 v[104:107], v226 offset:8192
    ds_read_b128 v[108:111], v226 offset:9216
    v_mfma_f32_32x32x16_bf16 v[20:35], v[128:131], v[136:139], v[20:35]
    ds_read_b64_tr_b16 v[112:113], v222 offset:16384
    ds_read_b64_tr_b16 v[114:115], v222 offset:17408
    ds_read_b64_tr_b16 v[116:117], v218 offset:16384
    v_mfma_f32_32x32x16_bf16 v[36:51], v[140:143], v[128:131], v[36:51]
    ds_read_b64_tr_b16 v[118:119], v218 offset:17408
    ds_read_b64_tr_b16 v[120:121], v214 offset:16384
    ds_read_b64_tr_b16 v[122:123], v214 offset:17408
    s_lshl_b32 s78, s91, 7
    s_add_u32 s92, s86, s78
    s_add_u32 s93, s87, s78
    s_mul_i32 s78, s91, 229376
    s_add_u32 s94, s88, s78
    s_add_u32 s91, s91, 1
    s_cmp_eq_u32 s91, 7
    s_cselect_b32 s91, 0, s91
    s_add_u32 m0, s89, 0
    v_fract_f32 v205, v201
    buffer_load_dwordx4 v249, s[12:15], s92 offen offset:0 lds
    v_cos_f32 v204, v205
    v_mfma_f32_32x32x16_bf16 v[52:67], v[144:147], v[128:131], v[52:67]
    ds_read_b64_tr_b16 v[124:125], v210 offset:16384
    ds_read_b64_tr_b16 v[126:127], v210 offset:17408
    buffer_load_dwordx4 v248, s[12:15], s92 offen offset:1024 lds
    v_sin_f32 v205, v205
    v_mfma_f32_32x32x16_bf16 v[68:83], v[148:151], v[128:131], v[68:83]
    buffer_load_dwordx4 v247, s[12:15], s92 offen offset:2048 lds
    v_mul_f32 v198, v206, v204
    v_mul_f32 v199, v206, v205
    v_mfma_f32_32x32x16_bf16 v[84:99], v[152:155], v[128:131], v[84:99]
    buffer_load_dwordx4 v246, s[12:15], s92 offen offset:3072 lds
    v_mul_f32 v206, 0x41800000, v202
    s_waitcnt lgkmcnt(0)
    v_mfma_f32_32x32x16_bf16 v[4:19], v[100:103], v[104:107], v[4:19]
    ds_read_b128 v[128:131], v229 offset:16384
    ds_read_b128 v[132:135], v225 offset:8192
    ds_read_b128 v[136:139], v225 offset:9216
    v_mfma_f32_32x32x16_bf16 v[20:35], v[100:103], v[108:111], v[20:35]
    ds_read_b64_tr_b16 v[140:141], v221 offset:16384
    ds_read_b64_tr_b16 v[142:143], v221 offset:17408
    ds_read_b64_tr_b16 v[144:145], v217 offset:16384
    v_mfma_f32_32x32x16_bf16 v[36:51], v[112:115], v[100:103], v[36:51]
    ds_read_b64_tr_b16 v[146:147], v217 offset:17408
    ds_read_b64_tr_b16 v[148:149], v213 offset:16384
    ds_read_b64_tr_b16 v[150:151], v213 offset:17408
    s_add_u32 m0, s90, 49152
    v_mul_f32 v205, 0x41800000, v201
    buffer_load_dwordx4 v245, s[16:19], s93 offen lds
    v_exp_f32 v206, v206
    v_mfma_f32_32x32x16_bf16 v[52:67], v[116:119], v[100:103], v[52:67]
    ds_read_b64_tr_b16 v[152:153], v209 offset:16384
    ds_read_b64_tr_b16 v[154:155], v209 offset:17408
    v_fract_f32 v205, v205
    v_mfma_f32_32x32x16_bf16 v[68:83], v[120:123], v[100:103], v[68:83]
    buffer_load_dwordx4 v245, s[20:23], s93 offen offset:1024 lds
    v_cos_f32 v204, v205
    v_sin_f32 v205, v205
    v_mfma_f32_32x32x16_bf16 v[84:99], v[124:127], v[100:103], v[84:99]
    v_mul_f32 v196, v206, v204
    v_dot2c_f32_bf16 v240, s95, v104
    v_dot2c_f32_bf16 v237, s95, v108
    v_dot2c_f32_bf16 v236, s95, v112
    v_dot2c_f32_bf16 v235, s95, v116
    v_dot2c_f32_bf16 v234, s95, v120
    v_dot2c_f32_bf16 v233, s95, v124
    v_dot2c_f32_bf16 v240, s95, v105
    v_dot2c_f32_bf16 v237, s95, v109
    v_dot2c_f32_bf16 v236, s95, v113
    v_dot2c_f32_bf16 v235, s95, v117
    v_dot2c_f32_bf16 v234, s95, v121
    v_dot2c_f32_bf16 v233, s95, v125
    v_dot2c_f32_bf16 v240, s95, v106
    v_dot2c_f32_bf16 v237, s95, v110
    v_dot2c_f32_bf16 v236, s95, v114
    v_dot2c_f32_bf16 v235, s95, v118
    v_dot2c_f32_bf16 v234, s95, v122
    v_dot2c_f32_bf16 v233, s95, v126
    v_dot2c_f32_bf16 v240, s95, v107
    v_dot2c_f32_bf16 v237, s95, v111
    v_dot2c_f32_bf16 v236, s95, v115
    v_dot2c_f32_bf16 v235, s95, v119
    v_dot2c_f32_bf16 v234, s95, v123
    v_dot2c_f32_bf16 v233, s95, v127
    s_waitcnt lgkmcnt(0)
    v_mfma_f32_32x32x16_bf16 v[4:19], v[128:131], v[132:135], v[4:19]
    ds_read_b128 v[100:103], v228 offset:16384
    ds_read_b128 v[104:107], v224 offset:8192
    ds_read_b128 v[108:111], v224 offset:9216
    v_mfma_f32_32x32x16_bf16 v[20:35], v[128:131], v[136:139], v[20:35]
    ds_read_b64_tr_b16 v[112:113], v220 offset:16384
    ds_read_b64_tr_b16 v[114:115], v220 offset:17408
    ds_read_b64_tr_b16 v[116:117], v216 offset:16384
    v_mfma_f32_32x32x16_bf16 v[36:51], v[140:143], v[128:131], v[36:51]
    ds_read_b64_tr_b16 v[118:119], v216 offset:17408
    ds_read_b64_tr_b16 v[120:121], v212 offset:16384
    ds_read_b64_tr_b16 v[122:123], v212 offset:17408
    s_add_u32 m0, s89, 73728
    v_mul_f32 v197, v206, v205
    buffer_load_dwordx4 v244, s[24:27], s94 offen offset:0 lds
    v_mul_f32 v206, 0x43000000, v202
    v_mfma_f32_32x32x16_bf16 v[52:67], v[144:147], v[128:131], v[52:67]
    ds_read_b64_tr_b16 v[124:125], v208 offset:16384
    ds_read_b64_tr_b16 v[126:127], v208 offset:17408
    buffer_load_dwordx4 v243, s[24:27], s94 offen offset:1024 lds
    v_mul_f32 v205, 0x43000000, v201
    v_mfma_f32_32x32x16_bf16 v[68:83], v[148:151], v[128:131], v[68:83]
    buffer_load_dwordx4 v242, s[24:27], s94 offen offset:2048 lds
    v_exp_f32 v206, v206
    v_fract_f32 v205, v205
    v_mfma_f32_32x32x16_bf16 v[84:99], v[152:155], v[128:131], v[84:99]
    buffer_load_dwordx4 v241, s[24:27], s94 offen offset:3072 lds
    v_cos_f32 v204, v205
    s_waitcnt lgkmcnt(0)
    v_mfma_f32_32x32x16_bf16 v[4:19], v[100:103], v[104:107], v[4:19]
    ds_read_b128 v[128:131], v227 offset:16384
    ds_read_b128 v[132:135], v223 offset:8192
    ds_read_b128 v[136:139], v223 offset:9216
    v_mfma_f32_32x32x16_bf16 v[20:35], v[100:103], v[108:111], v[20:35]
    ds_read_b64_tr_b16 v[140:141], v219 offset:16384
    ds_read_b64_tr_b16 v[142:143], v219 offset:17408
    ds_read_b64_tr_b16 v[144:145], v215 offset:16384
    v_mfma_f32_32x32x16_bf16 v[36:51], v[112:115], v[100:103], v[36:51]
    ds_read_b64_tr_b16 v[146:147], v215 offset:17408
    ds_read_b64_tr_b16 v[148:149], v211 offset:16384
    ds_read_b64_tr_b16 v[150:151], v211 offset:17408
    v_sin_f32 v205, v205
    v_mul_f32 v192, v206, v204
    v_mfma_f32_32x32x16_bf16 v[52:67], v[116:119], v[100:103], v[52:67]
    ds_read_b64_tr_b16 v[152:153], v207 offset:16384
    ds_read_b64_tr_b16 v[154:155], v207 offset:17408
    v_mul_f32 v193, v206, v205
    v_mfma_f32_32x32x16_bf16 v[68:83], v[120:123], v[100:103], v[68:83]
    v_mul_f32 v206, 0x43800000, v202
    v_mul_f32 v205, 0x43800000, v201
    v_mfma_f32_32x32x16_bf16 v[84:99], v[124:127], v[100:103], v[84:99]
    v_exp_f32 v206, v206
    s_waitcnt lgkmcnt(0)
    s_waitcnt vmcnt(10)
    s_barrier
    v_mfma_f32_32x32x16_bf16 v[4:19], v[128:131], v[132:135], v[4:19]
    ds_read_b128 v[100:103], v230 offset:32768
    ds_read_b128 v[104:107], v226 offset:16384
    ds_read_b128 v[108:111], v226 offset:17408
    v_mfma_f32_32x32x16_bf16 v[20:35], v[128:131], v[136:139], v[20:35]
    ds_read_b64_tr_b16 v[112:113], v222 offset:32768
    ds_read_b64_tr_b16 v[114:115], v222 offset:33792
    ds_read_b64_tr_b16 v[116:117], v218 offset:32768
    v_mfma_f32_32x32x16_bf16 v[36:51], v[140:143], v[128:131], v[36:51]
    ds_read_b64_tr_b16 v[118:119], v218 offset:33792
    ds_read_b64_tr_b16 v[120:121], v214 offset:32768
    ds_read_b64_tr_b16 v[122:123], v214 offset:33792
    s_lshl_b32 s78, s91, 7
    s_add_u32 s92, s86, s78
    s_add_u32 s93, s87, s78
    s_mul_i32 s78, s91, 229376
    s_add_u32 s94, s88, s78
    s_add_u32 s91, s91, 1
    s_cmp_eq_u32 s91, 7
    s_cselect_b32 s91, 0, s91
    s_add_u32 m0, s89, 16384
    v_fract_f32 v205, v205
    buffer_load_dwordx4 v249, s[12:15], s92 offen offset:0 lds
    v_cos_f32 v204, v205
    v_mfma_f32_32x32x16_bf16 v[52:67], v[144:147], v[128:131], v[52:67]
    ds_read_b64_tr_b16 v[124:125], v210 offset:32768
    ds_read_b64_tr_b16 v[126:127], v210 offset:33792
    buffer_load_dwordx4 v248, s[12:15], s92 offen offset:1024 lds
    v_sin_f32 v205, v205
    v_mfma_f32_32x32x16_bf16 v[68:83], v[148:151], v[128:131], v[68:83]
    buffer_load_dwordx4 v247, s[12:15], s92 offen offset:2048 lds
    v_mul_f32 v190, v206, v204
    v_mul_f32 v191, v206, v205
    v_mfma_f32_32x32x16_bf16 v[84:99], v[152:155], v[128:131], v[84:99]
    buffer_load_dwordx4 v246, s[12:15], s92 offen offset:3072 lds
    s_lshl_b32 s84, s3, 1
    s_waitcnt lgkmcnt(0)
    v_mfma_f32_32x32x16_bf16 v[4:19], v[100:103], v[104:107], v[4:19]
    ds_read_b128 v[128:131], v229 offset:32768
    ds_read_b128 v[132:135], v225 offset:16384
    ds_read_b128 v[136:139], v225 offset:17408
    v_mfma_f32_32x32x16_bf16 v[20:35], v[100:103], v[108:111], v[20:35]
    ds_read_b64_tr_b16 v[140:141], v221 offset:32768
    ds_read_b64_tr_b16 v[142:143], v221 offset:33792
    ds_read_b64_tr_b16 v[144:145], v217 offset:32768
    v_mfma_f32_32x32x16_bf16 v[36:51], v[112:115], v[100:103], v[36:51]
    ds_read_b64_tr_b16 v[146:147], v217 offset:33792
    ds_read_b64_tr_b16 v[148:149], v213 offset:32768
    ds_read_b64_tr_b16 v[150:151], v213 offset:33792
    s_add_u32 m0, s90, 57344
    v_add_lshl_u32 v203, v3, s84, 4
    buffer_load_dwordx4 v245, s[16:19], s93 offen lds
    v_cvt_f32_u32 v203, v203
    v_mfma_f32_32x32x16_bf16 v[52:67], v[116:119], v[100:103], v[52:67]
    ds_read_b64_tr_b16 v[152:153], v209 offset:32768
    ds_read_b64_tr_b16 v[154:155], v209 offset:33792
    v_mul_f32 v206, v203, v202
    v_mfma_f32_32x32x16_bf16 v[68:83], v[120:123], v[100:103], v[68:83]
    buffer_load_dwordx4 v245, s[20:23], s93 offen offset:1024 lds
    v_mul_f32 v205, v203, v201
    v_exp_f32 v206, v206
    v_mfma_f32_32x32x16_bf16 v[84:99], v[124:127], v[100:103], v[84:99]
    v_fract_f32 v205, v205
    v_dot2c_f32_bf16 v240, s95, v104
    v_dot2c_f32_bf16 v237, s95, v108
    v_dot2c_f32_bf16 v236, s95, v112
    v_dot2c_f32_bf16 v235, s95, v116
    v_dot2c_f32_bf16 v234, s95, v120
    v_dot2c_f32_bf16 v233, s95, v124
    v_dot2c_f32_bf16 v240, s95, v105
    v_dot2c_f32_bf16 v237, s95, v109
    v_dot2c_f32_bf16 v236, s95, v113
    v_dot2c_f32_bf16 v235, s95, v117
    v_dot2c_f32_bf16 v234, s95, v121
    v_dot2c_f32_bf16 v233, s95, v125
    v_dot2c_f32_bf16 v240, s95, v106
    v_dot2c_f32_bf16 v237, s95, v110
    v_dot2c_f32_bf16 v236, s95, v114
    v_dot2c_f32_bf16 v235, s95, v118
    v_dot2c_f32_bf16 v234, s95, v122
    v_dot2c_f32_bf16 v233, s95, v126
    v_dot2c_f32_bf16 v240, s95, v107
    v_dot2c_f32_bf16 v237, s95, v111
    v_dot2c_f32_bf16 v236, s95, v115
    v_dot2c_f32_bf16 v235, s95, v119
    v_dot2c_f32_bf16 v234, s95, v123
    v_dot2c_f32_bf16 v233, s95, v127
    s_waitcnt lgkmcnt(0)
    v_mfma_f32_32x32x16_bf16 v[4:19], v[128:131], v[132:135], v[4:19]
    ds_read_b128 v[100:103], v228 offset:32768
    ds_read_b128 v[104:107], v224 offset:16384
    ds_read_b128 v[108:111], v224 offset:17408
    v_mfma_f32_32x32x16_bf16 v[20:35], v[128:131], v[136:139], v[20:35]
    ds_read_b64_tr_b16 v[112:113], v220 offset:32768
    ds_read_b64_tr_b16 v[114:115], v220 offset:33792
    ds_read_b64_tr_b16 v[116:117], v216 offset:32768
    v_mfma_f32_32x32x16_bf16 v[36:51], v[140:143], v[128:131], v[36:51]
    ds_read_b64_tr_b16 v[118:119], v216 offset:33792
    ds_read_b64_tr_b16 v[120:121], v212 offset:32768
    ds_read_b64_tr_b16 v[122:123], v212 offset:33792
    s_add_u32 m0, s89, 90112
    v_cos_f32 v204, v205
    buffer_load_dwordx4 v244, s[24:27], s94 offen offset:0 lds
    v_sin_f32 v205, v205
    v_mfma_f32_32x32x16_bf16 v[52:67], v[144:147], v[128:131], v[52:67]
    ds_read_b64_tr_b16 v[124:125], v208 offset:32768
    ds_read_b64_tr_b16 v[126:127], v208 offset:33792
    buffer_load_dwordx4 v243, s[24:27], s94 offen offset:1024 lds
    v_mul_f32 v194, v206, v204
    v_mfma_f32_32x32x16_bf16 v[68:83], v[148:151], v[128:131], v[68:83]
    buffer_load_dwordx4 v242, s[24:27], s94 offen offset:2048 lds
    v_mul_f32 v195, v206, v205
    v_add_f32 v206, -1.0, v198
    v_mfma_f32_32x32x16_bf16 v[84:99], v[152:155], v[128:131], v[84:99]
    buffer_load_dwordx4 v241, s[24:27], s94 offen offset:3072 lds
    v_mul_f32 v205, v255, v255
    s_waitcnt lgkmcnt(0)
    v_mfma_f32_32x32x16_bf16 v[4:19], v[100:103], v[104:107], v[4:19]
    ds_read_b128 v[128:131], v227 offset:32768
    ds_read_b128 v[132:135], v223 offset:16384
    ds_read_b128 v[136:139], v223 offset:17408
    v_mfma_f32_32x32x16_bf16 v[20:35], v[100:103], v[108:111], v[20:35]
    ds_read_b64_tr_b16 v[140:141], v219 offset:32768
    ds_read_b64_tr_b16 v[142:143], v219 offset:33792
    ds_read_b64_tr_b16 v[144:145], v215 offset:32768
    v_mfma_f32_32x32x16_bf16 v[36:51], v[112:115], v[100:103], v[36:51]
    ds_read_b64_tr_b16 v[146:147], v215 offset:33792
    ds_read_b64_tr_b16 v[148:149], v211 offset:32768
    ds_read_b64_tr_b16 v[150:151], v211 offset:33792
    v_fmac_f32 v205, v254, v254
    v_rcp_f32 v205, v205
    v_mfma_f32_32x32x16_bf16 v[52:67], v[116:119], v[100:103], v[52:67]
    ds_read_b64_tr_b16 v[152:153], v207 offset:32768
    ds_read_b64_tr_b16 v[154:155], v207 offset:33792
    v_mul_f32 v204, v206, v255
    v_mfma_f32_32x32x16_bf16 v[68:83], v[120:123], v[100:103], v[68:83]
    v_add_f32 v205, v205, v205
    v_fma_f32 v204, -v199, v254, v204
    v_mfma_f32_32x32x16_bf16 v[84:99], v[124:127], v[100:103], v[84:99]
    v_mul_f32 v203, v206, v254
    s_waitcnt lgkmcnt(0)
    s_waitcnt vmcnt(10)
    s_barrier
    v_mfma_f32_32x32x16_bf16 v[4:19], v[128:131], v[132:135], v[4:19]
    ds_read_b128 v[100:103], v230 offset:0
    ds_read_b128 v[104:107], v226 offset:0
    ds_read_b128 v[108:111], v226 offset:1024
    v_mfma_f32_32x32x16_bf16 v[20:35], v[128:131], v[136:139], v[20:35]
    ds_read_b64_tr_b16 v[112:113], v222 offset:0
    ds_read_b64_tr_b16 v[114:115], v222 offset:1024
    ds_read_b64_tr_b16 v[116:117], v218 offset:0
    v_mfma_f32_32x32x16_bf16 v[36:51], v[140:143], v[128:131], v[36:51]
    ds_read_b64_tr_b16 v[118:119], v218 offset:1024
    ds_read_b64_tr_b16 v[120:121], v214 offset:0
    ds_read_b64_tr_b16 v[122:123], v214 offset:1024
    s_lshl_b32 s78, s91, 7
    s_add_u32 s92, s86, s78
    s_add_u32 s93, s87, s78
    s_mul_i32 s78, s91, 229376
    s_add_u32 s94, s88, s78
    s_add_u32 s91, s91, 1
    s_cmp_eq_u32 s91, 7
    s_cselect_b32 s91, 0, s91
    s_add_u32 m0, s89, 32768
    v_fmac_f32 v203, v199, v255
    buffer_load_dwordx4 v249, s[12:15], s92 offen offset:0 lds
    v_mul_f32 v188, v204, v205
    v_mfma_f32_32x32x16_bf16 v[52:67], v[144:147], v[128:131], v[52:67]
    ds_read_b64_tr_b16 v[124:125], v210 offset:0
    ds_read_b64_tr_b16 v[126:127], v210 offset:1024
    buffer_load_dwordx4 v248, s[12:15], s92 offen offset:1024 lds
    v_mul_f32 v189, v203, v205
    v_mfma_f32_32x32x16_bf16 v[68:83], v[148:151], v[128:131], v[68:83]
    buffer_load_dwordx4 v247, s[12:15], s92 offen offset:2048 lds
    v_lshrrev_b32 v206, 3, v2
    v_and_b32 v205, 3, v2
    v_mfma_f32_32x32x16_bf16 v[84:99], v[152:155], v[128:131], v[84:99]
    buffer_load_dwordx4 v246, s[12:15], s92 offen offset:3072 lds
    v_lshl_add_u32 v206, v206, 2, v205
    s_waitcnt lgkmcnt(0)
    v_mfma_f32_32x32x16_bf16 v[4:19], v[100:103], v[104:107], v[4:19]
    ds_read_b128 v[128:131], v229 offset:0
    ds_read_b128 v[132:135], v225 offset:0
    ds_read_b128 v[136:139], v225 offset:1024
    v_mfma_f32_32x32x16_bf16 v[20:35], v[100:103], v[108:111], v[20:35]
    ds_read_b64_tr_b16 v[140:141], v221 offset:0
    ds_read_b64_tr_b16 v[142:143], v221 offset:1024
    ds_read_b64_tr_b16 v[144:145], v217 offset:0
    v_mfma_f32_32x32x16_bf16 v[36:51], v[112:115], v[100:103], v[36:51]
    ds_read_b64_tr_b16 v[146:147], v217 offset:1024
    ds_read_b64_tr_b16 v[148:149], v213 offset:0
    ds_read_b64_tr_b16 v[150:151], v213 offset:1024
    s_add_u32 m0, s90, 65536
    v_bfe_u32 v205, v2, 2, 1
    buffer_load_dwordx4 v245, s[16:19], s93 offen lds
    v_and_b32 v203, 1, v206
    v_mfma_f32_32x32x16_bf16 v[52:67], v[116:119], v[100:103], v[52:67]
    ds_read_b64_tr_b16 v[152:153], v209 offset:0
    ds_read_b64_tr_b16 v[154:155], v209 offset:1024
    v_cmp_eq_u32 vcc, v205, v3
    v_mfma_f32_32x32x16_bf16 v[68:83], v[120:123], v[100:103], v[68:83]
    buffer_load_dwordx4 v245, s[20:23], s93 offen offset:1024 lds
    v_lshlrev_b32 v203, 4, v203
    v_mov_b32 v204, 0x3f80
    v_mfma_f32_32x32x16_bf16 v[84:99], v[124:127], v[100:103], v[84:99]
    v_lshlrev_b32 v204, v203, v204
    v_dot2c_f32_bf16 v240, s95, v104
    v_dot2c_f32_bf16 v237, s95, v108
    v_dot2c_f32_bf16 v236, s95, v112
    v_dot2c_f32_bf16 v235, s95, v116
    v_dot2c_f32_bf16 v234, s95, v120
    v_dot2c_f32_bf16 v233, s95, v124
    v_dot2c_f32_bf16 v240, s95, v105
    v_dot2c_f32_bf16 v237, s95, v109
    v_dot2c_f32_bf16 v236, s95, v113
    v_dot2c_f32_bf16 v235, s95, v117
    v_dot2c_f32_bf16 v234, s95, v121
    v_dot2c_f32_bf16 v233, s95, v125
    v_dot2c_f32_bf16 v240, s95, v106
    v_dot2c_f32_bf16 v237, s95, v110
    v_dot2c_f32_bf16 v236, s95, v114
    v_dot2c_f32_bf16 v235, s95, v118
    v_dot2c_f32_bf16 v234, s95, v122
    v_dot2c_f32_bf16 v233, s95, v126
    v_dot2c_f32_bf16 v240, s95, v107
    v_dot2c_f32_bf16 v237, s95, v111
    v_dot2c_f32_bf16 v236, s95, v115
    v_dot2c_f32_bf16 v235, s95, v119
    v_dot2c_f32_bf16 v234, s95, v123
    v_dot2c_f32_bf16 v233, s95, v127
    s_waitcnt lgkmcnt(0)
    v_mfma_f32_32x32x16_bf16 v[4:19], v[128:131], v[132:135], v[4:19]
    ds_read_b128 v[100:103], v228 offset:0
    ds_read_b128 v[104:107], v224 offset:0
    ds_read_b128 v[108:111], v224 offset:1024
    v_mfma_f32_32x32x16_bf16 v[20:35], v[128:131], v[136:139], v[20:35]
    ds_read_b64_tr_b16 v[112:113], v220 offset:0
    ds_read_b64_tr_b16 v[114:115], v220 offset:1024
    ds_read_b64_tr_b16 v[116:117], v216 offset:0
    v_mfma_f32_32x32x16_bf16 v[36:51], v[140:143], v[128:131], v[36:51]
    ds_read_b64_tr_b16 v[118:119], v216 offset:1024
    ds_read_b64_tr_b16 v[120:121], v212 offset:0
    ds_read_b64_tr_b16 v[122:123], v212 offset:1024
    s_add_u32 m0, s89, 106496
    v_cndmask_b32 v204, 0, v204, vcc
    buffer_load_dwordx4 v244, s[24:27], s94 offen offset:0 lds
    v_lshrrev_b32 v206, 1, v206
    v_mfma_f32_32x32x16_bf16 v[52:67], v[144:147], v[128:131], v[52:67]
    ds_read_b64_tr_b16 v[124:125], v208 offset:0
    ds_read_b64_tr_b16 v[126:127], v208 offset:1024
    buffer_load_dwordx4 v243, s[24:27], s94 offen offset:1024 lds
    v_cmp_eq_u32 vcc, 0, v206
    v_mfma_f32_32x32x16_bf16 v[68:83], v[148:151], v[128:131], v[68:83]
    buffer_load_dwordx4 v242, s[24:27], s94 offen offset:2048 lds
    v_cndmask_b32 v156, 0, v204, vcc
    v_cmp_eq_u32 vcc, 1, v206
    v_mfma_f32_32x32x16_bf16 v[84:99], v[152:155], v[128:131], v[84:99]
    buffer_load_dwordx4 v241, s[24:27], s94 offen offset:3072 lds
    v_cndmask_b32 v157, 0, v204, vcc
    s_waitcnt lgkmcnt(0)
    v_mfma_f32_32x32x16_bf16 v[4:19], v[100:103], v[104:107], v[4:19]
    ds_read_b128 v[128:131], v227 offset:0
    ds_read_b128 v[132:135], v223 offset:0
    ds_read_b128 v[136:139], v223 offset:1024
    v_mfma_f32_32x32x16_bf16 v[20:35], v[100:103], v[108:111], v[20:35]
    ds_read_b64_tr_b16 v[140:141], v219 offset:0
    ds_read_b64_tr_b16 v[142:143], v219 offset:1024
    ds_read_b64_tr_b16 v[144:145], v215 offset:0
    v_mfma_f32_32x32x16_bf16 v[36:51], v[112:115], v[100:103], v[36:51]
    ds_read_b64_tr_b16 v[146:147], v215 offset:1024
    ds_read_b64_tr_b16 v[148:149], v211 offset:0
    ds_read_b64_tr_b16 v[150:151], v211 offset:1024
    v_cmp_eq_u32 vcc, 2, v206
    s_nop 1
    v_cndmask_b32 v158, 0, v204, vcc
    v_mfma_f32_32x32x16_bf16 v[52:67], v[116:119], v[100:103], v[52:67]
    ds_read_b64_tr_b16 v[152:153], v207 offset:0
    ds_read_b64_tr_b16 v[154:155], v207 offset:1024
    v_cmp_eq_u32 vcc, 3, v206
    v_mfma_f32_32x32x16_bf16 v[68:83], v[120:123], v[100:103], v[68:83]
    s_nop 0
    v_cndmask_b32 v159, 0, v204, vcc
    v_cmp_eq_u32 vcc, 4, v206
    v_mfma_f32_32x32x16_bf16 v[84:99], v[124:127], v[100:103], v[84:99]
    s_nop 0
    v_cndmask_b32 v160, 0, v204, vcc
    s_waitcnt lgkmcnt(0)
    s_waitcnt vmcnt(10)
    s_barrier
    v_mfma_f32_32x32x16_bf16 v[4:19], v[128:131], v[132:135], v[4:19]
    ds_read_b128 v[100:103], v230 offset:16384
    ds_read_b128 v[104:107], v226 offset:8192
    ds_read_b128 v[108:111], v226 offset:9216
    v_mfma_f32_32x32x16_bf16 v[20:35], v[128:131], v[136:139], v[20:35]
    ds_read_b64_tr_b16 v[112:113], v222 offset:16384
    ds_read_b64_tr_b16 v[114:115], v222 offset:17408
    ds_read_b64_tr_b16 v[116:117], v218 offset:16384
    v_mfma_f32_32x32x16_bf16 v[36:51], v[140:143], v[128:131], v[36:51]
    ds_read_b64_tr_b16 v[118:119], v218 offset:17408
    ds_read_b64_tr_b16 v[120:121], v214 offset:16384
    ds_read_b64_tr_b16 v[122:123], v214 offset:17408
    s_lshl_b32 s78, s91, 7
    s_add_u32 s92, s86, s78
    s_add_u32 s93, s87, s78
    s_mul_i32 s78, s91, 229376
    s_add_u32 s94, s88, s78
    s_add_u32 s91, s91, 1
    s_cmp_eq_u32 s91, 7
    s_cselect_b32 s91, 0, s91
    s_add_u32 m0, s89, 0
    v_cmp_eq_u32 vcc, 5, v206
    buffer_load_dwordx4 v249, s[12:15], s92 offen offset:0 lds
    s_nop 0
    v_cndmask_b32 v161, 0, v204, vcc
    v_mfma_f32_32x32x16_bf16 v[52:67], v[144:147], v[128:131], v[52:67]
    ds_read_b64_tr_b16 v[124:125], v210 offset:16384
    ds_read_b64_tr_b16 v[126:127], v210 offset:17408
    buffer_load_dwordx4 v248, s[12:15], s92 offen offset:1024 lds
    v_cmp_eq_u32 vcc, 6, v206
    v_mfma_f32_32x32x16_bf16 v[68:83], v[148:151], v[128:131], v[68:83]
    buffer_load_dwordx4 v247, s[12:15], s92 offen offset:2048 lds
    v_cndmask_b32 v162, 0, v204, vcc
    v_cmp_eq_u32 vcc, 7, v206
    v_mfma_f32_32x32x16_bf16 v[84:99], v[152:155], v[128:131], v[84:99]
    buffer_load_dwordx4 v246, s[12:15], s92 offen offset:3072 lds
    v_cndmask_b32 v163, 0, v204, vcc
    s_waitcnt lgkmcnt(0)
    v_mfma_f32_32x32x16_bf16 v[4:19], v[100:103], v[104:107], v[4:19]
    ds_read_b128 v[128:131], v229 offset:16384
    ds_read_b128 v[132:135], v225 offset:8192
    ds_read_b128 v[136:139], v225 offset:9216
    v_mfma_f32_32x32x16_bf16 v[20:35], v[100:103], v[108:111], v[20:35]
    ds_read_b64_tr_b16 v[140:141], v221 offset:16384
    ds_read_b64_tr_b16 v[142:143], v221 offset:17408
    ds_read_b64_tr_b16 v[144:145], v217 offset:16384
    v_mfma_f32_32x32x16_bf16 v[36:51], v[112:115], v[100:103], v[36:51]
    ds_read_b64_tr_b16 v[146:147], v217 offset:17408
    ds_read_b64_tr_b16 v[148:149], v213 offset:16384
    ds_read_b64_tr_b16 v[150:151], v213 offset:17408
    s_add_u32 m0, s90, 49152
    v_sub_u32 v206, s4, v3
    buffer_load_dwordx4 v245, s[16:19], s93 offen lds
    v_cmp_lt_i32 s[60:61], 0, v206
    v_mfma_f32_32x32x16_bf16 v[52:67], v[116:119], v[100:103], v[52:67]
    ds_read_b64_tr_b16 v[152:153], v209 offset:16384
    ds_read_b64_tr_b16 v[154:155], v209 offset:17408
    v_cmp_lt_i32 s[62:63], 2, v206
    v_mfma_f32_32x32x16_bf16 v[68:83], v[120:123], v[100:103], v[68:83]
    buffer_load_dwordx4 v245, s[20:23], s93 offen offset:1024 lds
    v_cmp_lt_i32 s[64:65], 4, v206
    v_cmp_lt_i32 s[66:67], 6, v206
    v_mfma_f32_32x32x16_bf16 v[84:99], v[124:127], v[100:103], v[84:99]
    v_cmp_lt_i32 s[68:69], 8, v206
    v_dot2c_f32_bf16 v240, s95, v104
    v_dot2c_f32_bf16 v237, s95, v108
    v_dot2c_f32_bf16 v236, s95, v112
    v_dot2c_f32_bf16 v235, s95, v116
    v_dot2c_f32_bf16 v234, s95, v120
    v_dot2c_f32_bf16 v233, s95, v124
    v_dot2c_f32_bf16 v240, s95, v105
    v_dot2c_f32_bf16 v237, s95, v109
    v_dot2c_f32_bf16 v236, s95, v113
    v_dot2c_f32_bf16 v235, s95, v117
    v_dot2c_f32_bf16 v234, s95, v121
    v_dot2c_f32_bf16 v233, s95, v125
    v_dot2c_f32_bf16 v240, s95, v106
    v_dot2c_f32_bf16 v237, s95, v110
    v_dot2c_f32_bf16 v236, s95, v114
    v_dot2c_f32_bf16 v235, s95, v118
    v_dot2c_f32_bf16 v234, s95, v122
    v_dot2c_f32_bf16 v233, s95, v126
    v_dot2c_f32_bf16 v240, s95, v107
    v_dot2c_f32_bf16 v237, s95, v111
    v_dot2c_f32_bf16 v236, s95, v115
    v_dot2c_f32_bf16 v235, s95, v119
    v_dot2c_f32_bf16 v234, s95, v123
    v_dot2c_f32_bf16 v233, s95, v127
    s_waitcnt lgkmcnt(0)
    v_mfma_f32_32x32x16_bf16 v[4:19], v[128:131], v[132:135], v[4:19]
    ds_read_b128 v[100:103], v228 offset:16384
    ds_read_b128 v[104:107], v224 offset:8192
    ds_read_b128 v[108:111], v224 offset:9216
    v_mfma_f32_32x32x16_bf16 v[20:35], v[128:131], v[136:139], v[20:35]
    ds_read_b64_tr_b16 v[112:113], v220 offset:16384
    ds_read_b64_tr_b16 v[114:115], v220 offset:17408
    ds_read_b64_tr_b16 v[116:117], v216 offset:16384
    v_mfma_f32_32x32x16_bf16 v[36:51], v[140:143], v[128:131], v[36:51]
    ds_read_b64_tr_b16 v[118:119], v216 offset:17408
    ds_read_b64_tr_b16 v[120:121], v212 offset:16384
    ds_read_b64_tr_b16 v[122:123], v212 offset:17408
    s_add_u32 m0, s89, 73728
    v_cmp_lt_i32 s[70:71], 10, v206
    buffer_load_dwordx4 v244, s[24:27], s94 offen offset:0 lds
    v_cmp_lt_i32 s[72:73], 12, v206
    v_mfma_f32_32x32x16_bf16 v[52:67], v[144:147], v[128:131], v[52:67]
    ds_read_b64_tr_b16 v[124:125], v208 offset:16384
    ds_read_b64_tr_b16 v[126:127], v208 offset:17408
    buffer_load_dwordx4 v243, s[24:27], s94 offen offset:1024 lds
    v_cmp_lt_i32 s[74:75], 14, v206
    v_mfma_f32_32x32x16_bf16 v[68:83], v[148:151], v[128:131], v[68:83]
    buffer_load_dwordx4 v242, s[24:27], s94 offen offset:2048 lds
    s_mov_b32 s97, s96
    s_mul_i32 s96, s96, 0x9E3779B1
    v_mfma_f32_32x32x16_bf16 v[84:99], v[152:155], v[128:131], v[84:99]
    buffer_load_dwordx4 v241, s[24:27], s94 offen offset:3072 lds
    s_add_u32 s96, s96, 0x7F4A7C15
    s_waitcnt lgkmcnt(0)
    v_mfma_f32_32x32x16_bf16 v[4:19], v[100:103], v[104:107], v[4:19]
    ds_read_b128 v[128:131], v227 offset:16384
    ds_read_b128 v[132:135], v223 offset:8192
    ds_read_b128 v[136:139], v223 offset:9216
    v_mfma_f32_32x32x16_bf16 v[20:35], v[100:103], v[108:111], v[20:35]
    ds_read_b64_tr_b16 v[140:141], v219 offset:16384
    ds_read_b64_tr_b16 v[142:143], v219 offset:17408
    ds_read_b64_tr_b16 v[144:145], v215 offset:16384
    v_mfma_f32_32x32x16_bf16 v[36:51], v[112:115], v[100:103], v[36:51]
    ds_read_b64_tr_b16 v[146:147], v215 offset:17408
    ds_read_b64_tr_b16 v[148:149], v211 offset:16384
    ds_read_b64_tr_b16 v[150:151], v211 offset:17408
    buffer_load_dwordx4 v[164:167], v200, s[28:31], s79 offen sc1
    v_mfma_f32_32x32x16_bf16 v[52:67], v[116:119], v[100:103], v[52:67]
    ds_read_b64_tr_b16 v[152:153], v207 offset:16384
    ds_read_b64_tr_b16 v[154:155], v207 offset:17408
    v_mfma_f32_32x32x16_bf16 v[68:83], v[120:123], v[100:103], v[68:83]
    v_mfma_f32_32x32x16_bf16 v[84:99], v[124:127], v[100:103], v[84:99]
    s_waitcnt lgkmcnt(0)
    s_waitcnt vmcnt(11)
    s_barrier
    v_mfma_f32_32x32x16_bf16 v[4:19], v[128:131], v[132:135], v[4:19]
    ds_read_b128 v[100:103], v230 offset:32768
    ds_read_b128 v[104:107], v226 offset:16384
    ds_read_b128 v[108:111], v226 offset:17408
    v_mfma_f32_32x32x16_bf16 v[20:35], v[128:131], v[136:139], v[20:35]
    ds_read_b64_tr_b16 v[112:113], v222 offset:32768
    ds_read_b64_tr_b16 v[114:115], v222 offset:33792
    ds_read_b64_tr_b16 v[116:117], v218 offset:32768
    s_movk_i32 s84, 896
    v_lshrrev_b32 v255, 3, v1
    v_mul_u32_u24 v255, s84, v255
    v_bfe_u32 v254, v1, 4, 1
    v_lshlrev_b32 v254, 2, v254
    v_and_b32 v253, 7, v1
    v_mfma_f32_32x32x16_bf16 v[36:51], v[140:143], v[128:131], v[36:51]
    ds_read_b64_tr_b16 v[118:119], v218 offset:33792
    ds_read_b64_tr_b16 v[120:121], v214 offset:32768
    ds_read_b64_tr_b16 v[122:123], v214 offset:33792
    buffer_load_dword v251, v251, s[40:43], 0 offen
    v_xor_b32 v254, v254, v253
    v_lshl_add_u32 v206, v254, 4, v255
    v_add_u32 v205, 6144, v206
    v_add_u32 v204, 12288, v206
    v_add_u32 v203, 18432, v206
    v_mfma_f32_32x32x16_bf16 v[52:67], v[144:147], v[128:131], v[52:67]
    ds_read_b64_tr_b16 v[124:125], v210 offset:32768
    ds_read_b64_tr_b16 v[126:127], v210 offset:33792
    v_lshrrev_b32 v254, 4, v1
    v_xor_b32 v254, v254, v253
    v_lshl_add_u32 v202, v254, 4, v255
    v_xor_b32 v254, 4, v254
    v_lshl_add_u32 v201, v254, 4, v255
    v_mfma_f32_32x32x16_bf16 v[68:83], v[148:151], v[128:131], v[68:83]
    v_add_u32 v201, 6144, v201
    v_add_u32 v187, 12288, v202
    v_add_u32 v186, 12288, v201
    s_mul_i32 s44, s3, 36864
    s_and_b32 s85, s3, 1
    v_mfma_f32_32x32x16_bf16 v[84:99], v[152:155], v[128:131], v[84:99]
    s_lshl_b32 s52, s3, 13
    s_add_u32 s52, s52, 122880
    v_bfe_u32 v255, v1, 2, 2
    v_lshl_add_u32 v254, v3, 3, v255
    v_lshlrev_b32 v254, 7, v254
    s_waitcnt lgkmcnt(0)
    v_mfma_f32_32x32x16_bf16 v[4:19], v[100:103], v[104:107], v[4:19]
    ds_read_b128 v[128:131], v229 offset:32768
    ds_read_b128 v[132:135], v225 offset:16384
    ds_read_b128 v[136:139], v225 offset:17408
    v_mfma_f32_32x32x16_bf16 v[20:35], v[100:103], v[108:111], v[20:35]
    ds_read_b64_tr_b16 v[140:141], v221 offset:32768
    ds_read_b64_tr_b16 v[142:143], v221 offset:33792
    ds_read_b64_tr_b16 v[144:145], v217 offset:32768
    v_bfe_u32 v253, v1, 4, 1
    v_lshlrev_b32 v253, 1, v253
    v_bfe_u32 v252, v1, 1, 1
    v_add_u32 v253, v253, v252
    v_lshl_add_u32 v254, v253, 4, v254
    v_and_b32 v252, 1, v1
    v_mfma_f32_32x32x16_bf16 v[36:51], v[112:115], v[100:103], v[36:51]
    ds_read_b64_tr_b16 v[146:147], v217 offset:33792
    ds_read_b64_tr_b16 v[148:149], v213 offset:32768
    ds_read_b64_tr_b16 v[150:151], v213 offset:33792
    buffer_load_dword v250, v250, s[36:39], 0 offen
    v_lshl_add_u32 v254, v252, 3, v254
    v_lshrrev_b32 v255, 1, v255
    v_xor_b32 v255, s85, v255
    v_xor_b32 v253, 0, v255
    v_lshl_add_u32 v253, v253, 6, v254
    v_mfma_f32_32x32x16_bf16 v[52:67], v[116:119], v[100:103], v[52:67]
    ds_read_b64_tr_b16 v[152:153], v209 offset:32768
    ds_read_b64_tr_b16 v[154:155], v209 offset:33792
    v_add_u32 v185, s44, v253
    v_xor_b32 v253, 1, v255
    v_lshl_add_u32 v253, v253, 6, v254
    v_add_u32 v184, s44, v253
    v_lshlrev_b32 v255, 7, v2
    v_mfma_f32_32x32x16_bf16 v[68:83], v[120:123], v[100:103], v[68:83]
    v_add_u32 v255, s44, v255
    v_bfe_u32 v254, v2, 1, 3
    v_xor_b32 v254, v254, v3
    s_lshl_b32 s84, s85, 2
    v_xor_b32 v254, s84, v254
    v_mfma_f32_32x32x16_bf16 v[84:99], v[124:127], v[100:103], v[84:99]
    s_lshl_b32 s84, s85, 12
    s_xor_b32 s83, s84, 4096
    v_xor_b32 v253, 0, v254
    v_lshl_add_u32 v253, v253, 4, v255
    v_add_u32 v183, s84, v253
    v_dot2c_f32_bf16 v240, s95, v104
    v_dot2c_f32_bf16 v237, s95, v108
    v_dot2c_f32_bf16 v236, s95, v112
    v_dot2c_f32_bf16 v235, s95, v116
    v_dot2c_f32_bf16 v234, s95, v120
    v_dot2c_f32_bf16 v233, s95, v124
    v_dot2c_f32_bf16 v240, s95, v105
    v_dot2c_f32_bf16 v237, s95, v109
    v_dot2c_f32_bf16 v236, s95, v113
    v_dot2c_f32_bf16 v235, s95, v117
    v_dot2c_f32_bf16 v234, s95, v121
    v_dot2c_f32_bf16 v233, s95, v125
    v_dot2c_f32_bf16 v240, s95, v106
    v_dot2c_f32_bf16 v237, s95, v110
    v_dot2c_f32_bf16 v236, s95, v114
    v_dot2c_f32_bf16 v235, s95, v118
    v_dot2c_f32_bf16 v234, s95, v122
    v_dot2c_f32_bf16 v233, s95, v126
    v_dot2c_f32_bf16 v240, s95, v107
    v_dot2c_f32_bf16 v237, s95, v111
    v_dot2c_f32_bf16 v236, s95, v115
    v_dot2c_f32_bf16 v235, s95, v119
    v_dot2c_f32_bf16 v234, s95, v123
    v_dot2c_f32_bf16 v233, s95, v127
    s_waitcnt lgkmcnt(0)
    s_mov_b32 s82, 0
L_st_chk:
    s_waitcnt vmcnt(2)
    v_cmp_ne_u32 vcc, s96, v167
    s_nop 4
    s_cbranch_vccz L_st_ok
    s_add_u32 s82, s82, 1
    s_cmp_gt_u32 s82, 0x8000
    s_cbranch_scc1 L_st_ok
    s_sleep 1
    buffer_load_dwordx4 v[164:167], v200, s[28:31], s79 offen sc1
    s_waitcnt vmcnt(0)
    s_branch L_st_chk
L_st_ok:
    v_mfma_f32_32x32x16_bf16 v[4:19], v[128:131], v[132:135], v[4:19]
    ds_read_b128 v[100:103], v228 offset:32768
    ds_read_b128 v[104:107], v224 offset:16384
    ds_read_b128 v[108:111], v224 offset:17408
    v_mfma_f32_32x32x16_bf16 v[20:35], v[128:131], v[136:139], v[20:35]
    ds_read_b64_tr_b16 v[112:113], v220 offset:32768
    ds_read_b64_tr_b16 v[114:115], v220 offset:33792
    ds_read_b64_tr_b16 v[116:117], v216 offset:32768
    v_add_u32 v182, s83, v253
    v_xor_b32 v253, 2, v254
    v_lshl_add_u32 v253, v253, 4, v255
    v_add_u32 v181, s84, v253
    v_add_u32 v180, s83, v253
    v_xor_b32 v253, 4, v254
    v_mfma_f32_32x32x16_bf16 v[36:51], v[140:143], v[128:131], v[36:51]
    ds_read_b64_tr_b16 v[118:119], v216 offset:33792
    ds_read_b64_tr_b16 v[120:121], v212 offset:32768
    ds_read_b64_tr_b16 v[122:123], v212 offset:33792
    v_lshl_add_u32 v253, v253, 4, v255
    v_add_u32 v179, s84, v253
    v_add_u32 v178, s83, v253
    v_xor_b32 v253, 6, v254
    v_lshl_add_u32 v253, v253, 4, v255
    v_mfma_f32_32x32x16_bf16 v[52:67], v[144:147], v[128:131], v[52:67]
    ds_read_b64_tr_b16 v[124:125], v208 offset:32768
    ds_read_b64_tr_b16 v[126:127], v208 offset:33792
    v_add_u32 v177, s84, v253
    v_add_u32 v176, s83, v253
    s_mul_i32 s45, s3, 401408
    s_lshl_b32 s84, s7, 7
    s_add_u32 s45, s45, s84
    v_mfma_f32_32x32x16_bf16 v[68:83], v[148:151], v[128:131], v[68:83]
    s_mul_i32 s46, s7, 57344
    s_and_b32 s84, s2, 7
    s_mul_i32 s47, s84, 7
    s_lshr_b32 s47, s47, 2
    s_mul_i32 s48, s84, 43
    v_mfma_f32_32x32x16_bf16 v[84:99], v[152:155], v[128:131], v[84:99]
    s_lshr_b32 s48, s48, 7
    s_mul_i32 s48, s48, 3
    s_sub_u32 s48, s84, s48
    s_mov_b32 s49, s47
    s_mov_b32 s50, s48
    s_waitcnt lgkmcnt(0)
    v_mfma_f32_32x32x16_bf16 v[4:19], v[100:103], v[104:107], v[4:19]
    ds_read_b128 v[128:131], v227 offset:32768
    ds_read_b128 v[132:135], v223 offset:16384
    ds_read_b128 v[136:139], v223 offset:17408
    v_mfma_f32_32x32x16_bf16 v[20:35], v[100:103], v[108:111], v[20:35]
    ds_read_b64_tr_b16 v[140:141], v219 offset:32768
    ds_read_b64_tr_b16 v[142:143], v219 offset:33792
    ds_read_b64_tr_b16 v[144:145], v215 offset:32768
    v_mul_f32 v253, v164, v165
    v_mov_b32 v254, v166
    v_mfma_f32_32x32x16_bf16 v[36:51], v[112:115], v[100:103], v[36:51]
    ds_read_b64_tr_b16 v[146:147], v215 offset:33792
    ds_read_b64_tr_b16 v[148:149], v211 offset:32768
    ds_read_b64_tr_b16 v[150:151], v211 offset:33792
    v_mul_f32 v255, v166, v164
    s_lshl_b32 s84, s3, 8
    v_mfma_f32_32x32x16_bf16 v[52:67], v[116:119], v[100:103], v[52:67]
    ds_read_b64_tr_b16 v[152:153], v207 offset:32768
    ds_read_b64_tr_b16 v[154:155], v207 offset:33792
    s_add_u32 s83, s84, 157184
    v_lshl_add_u32 v252, v232, 2, s83
    v_mfma_f32_32x32x16_bf16 v[68:83], v[120:123], v[100:103], v[68:83]
    ds_write_b32 v252, v165 offset:3072
    ds_write_b32 v252, v253 offset:3200
    v_mfma_f32_32x32x16_bf16 v[84:99], v[124:127], v[100:103], v[84:99]
    v_lshl_add_u32 v248, v3, 6, s83
    s_waitcnt lgkmcnt(0)
    s_barrier
    v_mfma_f32_32x32x16_bf16 v[4:19], v[128:131], v[132:135], v[4:19]
    ds_read_b128 v[100:103], v230 offset:0
    ds_read_b128 v[104:107], v226 offset:0
    ds_read_b128 v[108:111], v226 offset:1024
    v_mfma_f32_32x32x16_bf16 v[20:35], v[128:131], v[136:139], v[20:35]
    ds_read_b64_tr_b16 v[112:113], v222 offset:0
    ds_read_b64_tr_b16 v[114:115], v222 offset:1024
    ds_read_b64_tr_b16 v[116:117], v218 offset:0
    v_mfma_f32_32x32x16_bf16 v[36:51], v[140:143], v[128:131], v[36:51]
    ds_read_b64_tr_b16 v[118:119], v218 offset:1024
    ds_read_b64_tr_b16 v[120:121], v214 offset:0
    ds_read_b64_tr_b16 v[122:123], v214 offset:1024
    v_mfma_f32_32x32x16_bf16 v[52:67], v[144:147], v[128:131], v[52:67]
    ds_read_b64_tr_b16 v[124:125], v210 offset:0
    ds_read_b64_tr_b16 v[126:127], v210 offset:1024
    v_mfma_f32_32x32x16_bf16 v[68:83], v[148:151], v[128:131], v[68:83]
    v_mfma_f32_32x32x16_bf16 v[84:99], v[152:155], v[128:131], v[84:99]
    s_waitcnt lgkmcnt(0)
    v_mfma_f32_32x32x16_bf16 v[4:19], v[100:103], v[104:107], v[4:19]
    ds_read_b128 v[128:131], v229 offset:0
    ds_read_b128 v[132:135], v225 offset:0
    ds_read_b128 v[136:139], v225 offset:1024
    v_mfma_f32_32x32x16_bf16 v[20:35], v[100:103], v[108:111], v[20:35]
    ds_read_b64_tr_b16 v[140:141], v221 offset:0
    ds_read_b64_tr_b16 v[142:143], v221 offset:1024
    ds_read_b64_tr_b16 v[144:145], v217 offset:0
    v_mfma_f32_32x32x16_bf16 v[36:51], v[112:115], v[100:103], v[36:51]
    ds_read_b64_tr_b16 v[146:147], v217 offset:1024
    ds_read_b64_tr_b16 v[148:149], v213 offset:0
    ds_read_b64_tr_b16 v[150:151], v213 offset:1024
    v_mfma_f32_32x32x16_bf16 v[52:67], v[116:119], v[100:103], v[52:67]
    ds_read_b64_tr_b16 v[152:153], v209 offset:0
    ds_read_b64_tr_b16 v[154:155], v209 offset:1024
    v_mfma_f32_32x32x16_bf16 v[68:83], v[120:123], v[100:103], v[68:83]
    v_mfma_f32_32x32x16_bf16 v[84:99], v[124:127], v[100:103], v[84:99]
    v_dot2c_f32_bf16 v240, s95, v104
    v_dot2c_f32_bf16 v237, s95, v108
    v_dot2c_f32_bf16 v236, s95, v112
    v_dot2c_f32_bf16 v235, s95, v116
    v_dot2c_f32_bf16 v234, s95, v120
    v_dot2c_f32_bf16 v233, s95, v124
    v_dot2c_f32_bf16 v240, s95, v105
    v_dot2c_f32_bf16 v237, s95, v109
    v_dot2c_f32_bf16 v236, s95, v113
    v_dot2c_f32_bf16 v235, s95, v117
    v_dot2c_f32_bf16 v234, s95, v121
    v_dot2c_f32_bf16 v233, s95, v125
    v_dot2c_f32_bf16 v240, s95, v106
    v_dot2c_f32_bf16 v237, s95, v110
    v_dot2c_f32_bf16 v236, s95, v114
    v_dot2c_f32_bf16 v235, s95, v118
    v_dot2c_f32_bf16 v234, s95, v122
    v_dot2c_f32_bf16 v233, s95, v126
    v_dot2c_f32_bf16 v240, s95, v107
    v_dot2c_f32_bf16 v237, s95, v111
    v_dot2c_f32_bf16 v236, s95, v115
    v_dot2c_f32_bf16 v235, s95, v119
    v_dot2c_f32_bf16 v234, s95, v123
    v_dot2c_f32_bf16 v233, s95, v127
    s_waitcnt lgkmcnt(0)
    v_mfma_f32_32x32x16_bf16 v[4:19], v[128:131], v[132:135], v[4:19]
    ds_read_b128 v[100:103], v228 offset:0
    ds_read_b128 v[104:107], v224 offset:0
    ds_read_b128 v[108:111], v224 offset:1024
    v_mfma_f32_32x32x16_bf16 v[20:35], v[128:131], v[136:139], v[20:35]
    ds_read_b64_tr_b16 v[112:113], v220 offset:0
    ds_read_b64_tr_b16 v[114:115], v220 offset:1024
    ds_read_b64_tr_b16 v[116:117], v216 offset:0
    v_mov_b32 v247, v240
    v_mov_b32 v246, v237
    v_mov_b32 v245, v236
    v_mov_b32 v244, v235
    v_mov_b32 v243, v234
    v_mov_b32 v242, v233
    v_mfma_f32_32x32x16_bf16 v[36:51], v[140:143], v[128:131], v[36:51]
    ds_read_b64_tr_b16 v[118:119], v216 offset:1024
    ds_read_b64_tr_b16 v[120:121], v212 offset:0
    ds_read_b64_tr_b16 v[122:123], v212 offset:1024
    s_lshl_b32 s84, s3, 2
    s_add_u32 s85, s84, 157184
    v_lshl_add_u32 v253, v2, 4, s85
    v_lshl_add_u32 v252, v231, 4, s85
    v_permlane32_swap_b32 v240, v247
    v_permlane32_swap_b32 v237, v246
    v_mfma_f32_32x32x16_bf16 v[52:67], v[144:147], v[128:131], v[52:67]
    ds_read_b64_tr_b16 v[124:125], v208 offset:0
    ds_read_b64_tr_b16 v[126:127], v208 offset:1024
    v_permlane32_swap_b32 v236, v245
    v_permlane32_swap_b32 v235, v244
    v_permlane32_swap_b32 v234, v243
    v_permlane32_swap_b32 v233, v242
    v_add_f32 v240, v240, v247
    v_mfma_f32_32x32x16_bf16 v[68:83], v[148:151], v[128:131], v[68:83]
    v_add_f32 v237, v237, v246
    v_add_f32 v236, v236, v245
    v_add_f32 v235, v235, v244
    v_add_f32 v234, v234, v243
    v_add_f32 v233, v233, v242
    ds_write_b32 v253, v240 offset:0
    v_mfma_f32_32x32x16_bf16 v[84:99], v[152:155], v[128:131], v[84:99]
    ds_write_b32 v253, v237 offset:512
    ds_write_b32 v252, v236 offset:1024
    ds_write_b32 v252, v235 offset:1536
    ds_write_b32 v252, v234 offset:2048
    ds_write_b32 v252, v233 offset:2560
    s_waitcnt lgkmcnt(0)
    s_barrier
    v_mfma_f32_32x32x16_bf16 v[4:19], v[100:103], v[104:107], v[4:19]
    ds_read_b128 v[128:131], v227 offset:0
    ds_read_b128 v[132:135], v223 offset:0
    ds_read_b128 v[136:139], v223 offset:1024
    v_mfma_f32_32x32x16_bf16 v[20:35], v[100:103], v[108:111], v[20:35]
    ds_read_b64_tr_b16 v[140:141], v219 offset:0
    ds_read_b64_tr_b16 v[142:143], v219 offset:1024
    ds_read_b64_tr_b16 v[144:145], v215 offset:0
    s_mov_b32 s85, 157184
    v_lshl_add_u32 v253, v2, 4, s85
    v_mfma_f32_32x32x16_bf16 v[36:51], v[112:115], v[100:103], v[36:51]
    ds_read_b64_tr_b16 v[146:147], v215 offset:1024
    ds_read_b64_tr_b16 v[148:149], v211 offset:0
    ds_read_b64_tr_b16 v[150:151], v211 offset:1024
    v_lshl_add_u32 v252, v1, 4, s85
    ds_read_b128 v[164:167], v253 offset:0
    v_mfma_f32_32x32x16_bf16 v[52:67], v[116:119], v[100:103], v[52:67]
    ds_read_b64_tr_b16 v[152:153], v207 offset:0
    ds_read_b64_tr_b16 v[154:155], v207 offset:1024
    ds_read_b128 v[168:171], v253 offset:512
    ds_read_b128 v[172:175], v252 offset:1024
    v_mfma_f32_32x32x16_bf16 v[68:83], v[120:123], v[100:103], v[68:83]
    ds_read_b128 v[236:239], v252 offset:2048
    s_lshl_b32 s84, s3, 9
    v_mfma_f32_32x32x16_bf16 v[84:99], v[124:127], v[100:103], v[84:99]
    s_add_u32 s84, s84, 157184
    v_lshl_add_u32 v249, v1, 2, s84
    s_waitcnt lgkmcnt(0)
    s_barrier
    v_mfma_f32_32x32x16_bf16 v[4:19], v[128:131], v[132:135], v[4:19]
    ds_read_b128 v[100:103], v248 offset:3072
    ds_read_b128 v[104:107], v248 offset:3088
    ds_read_b128 v[108:111], v248 offset:3104
    ds_read_b128 v[112:115], v248 offset:3120
    v_mfma_f32_32x32x16_bf16 v[20:35], v[128:131], v[136:139], v[20:35]
    ds_read_b128 v[208:211], v248 offset:3200
    ds_read_b128 v[212:215], v248 offset:3216
    ds_read_b128 v[216:219], v248 offset:3232
    ds_read_b128 v[220:223], v248 offset:3248
    v_mfma_f32_32x32x16_bf16 v[36:51], v[140:143], v[128:131], v[36:51]
    v_add_f32 v164, v164, v165
    v_add_f32 v166, v166, v167
    v_add_f32 v168, v168, v169
    s_mul_i32 s51, s49, 28672
    s_add_u32 m0, s44, 0
    s_add_u32 s51, s51, s45
    s_add_u32 s49, s49, 1
    s_cmp_eq_u32 s49, 14
    s_cselect_b32 s49, 0, s49
    buffer_load_dwordx4 v206, s[36:39], s51 offen offset:0 lds
    v_mfma_f32_32x32x16_bf16 v[52:67], v[144:147], v[128:131], v[52:67]
    v_add_f32 v170, v170, v171
    v_add_f32 v172, v172, v173
    v_add_f32 v174, v174, v175
    v_add_f32 v236, v236, v237
    buffer_load_dwordx4 v205, s[36:39], s51 offen offset:1024 lds
    v_mfma_f32_32x32x16_bf16 v[68:83], v[148:151], v[128:131], v[68:83]
    v_add_f32 v238, v238, v239
    v_add_f32 v246, v164, v166
    v_add_f32 v247, v168, v170
    v_add_f32 v172, v172, v174
    buffer_load_dwordx4 v204, s[36:39], s51 offen offset:2048 lds
    v_mfma_f32_32x32x16_bf16 v[84:99], v[152:155], v[128:131], v[84:99]
    v_add_f32 v236, v236, v238
    ds_write_b32 v249, v172 offset:4096
    ds_write_b32 v249, v236 offset:4352
    buffer_load_dwordx4 v203, s[36:39], s51 offen offset:3072 lds
    v_mul_f32 v252, v188, v246
    v_mul_f32 v253, v189, v246
    v_fmac_f32 v252, v189, v247
    v_fma_f32 v253, -v188, v247, v253
    s_waitcnt vmcnt(4)
    v_pk_mul_f32 v[250:251], v[4:5], v[188:189] op_sel_hi:[1,0]
    v_pk_mul_f32 v[248:249], v[4:5], v[188:189] op_sel:[0,1] op_sel_hi:[1,1]
    v_pk_fma_f32 v[250:251], v[20:21], v[188:189], v[250:251] op_sel:[0,1,0] op_sel_hi:[1,1,1]
    v_pk_fma_f32 v[248:249], v[20:21], v[188:189], v[248:249] op_sel_hi:[1,0,1] neg_lo:[0,1,0] neg_hi:[0,1,0]
    s_waitcnt lgkmcnt(5)
    v_pk_mul_f32 v[4:5], v[208:209], v[252:253] op_sel_hi:[1,0]
    v_pk_mul_f32 v[20:21], v[208:209], v[252:253] op_sel:[0,1] op_sel_hi:[1,1]
    v_pk_fma_f32 v[4:5], v[100:101], v[250:251], v[4:5] neg_lo:[0,0,1] neg_hi:[0,0,1]
    v_pk_fma_f32 v[20:21], v[100:101], v[248:249], v[20:21] neg_lo:[0,0,1] neg_hi:[0,0,1]
    v_pk_mul_f32 v[250:251], v[6:7], v[188:189] op_sel_hi:[1,0]
    v_pk_mul_f32 v[248:249], v[6:7], v[188:189] op_sel:[0,1] op_sel_hi:[1,1]
    v_pk_fma_f32 v[250:251], v[22:23], v[188:189], v[250:251] op_sel:[0,1,0] op_sel_hi:[1,1,1]
    v_pk_fma_f32 v[248:249], v[22:23], v[188:189], v[248:249] op_sel_hi:[1,0,1] neg_lo:[0,1,0] neg_hi:[0,1,0]
    v_pk_mul_f32 v[6:7], v[210:211], v[252:253] op_sel_hi:[1,0]
    v_pk_mul_f32 v[22:23], v[210:211], v[252:253] op_sel:[0,1] op_sel_hi:[1,1]
    v_pk_fma_f32 v[6:7], v[102:103], v[250:251], v[6:7] neg_lo:[0,0,1] neg_hi:[0,0,1]
    v_pk_fma_f32 v[22:23], v[102:103], v[248:249], v[22:23] neg_lo:[0,0,1] neg_hi:[0,0,1]
    v_pk_mul_f32 v[250:251], v[8:9], v[188:189] op_sel_hi:[1,0]
    s_mul_i32 s51, s49, 28672
    s_add_u32 m0, s44, 4096
    s_add_u32 s51, s51, s45
    s_add_u32 s49, s49, 1
    s_cmp_eq_u32 s49, 14
    s_cselect_b32 s49, 0, s49
    buffer_load_dwordx4 v206, s[36:39], s51 offen offset:0 lds
    v_pk_mul_f32 v[248:249], v[8:9], v[188:189] op_sel:[0,1] op_sel_hi:[1,1]
    v_pk_fma_f32 v[250:251], v[24:25], v[188:189], v[250:251] op_sel:[0,1,0] op_sel_hi:[1,1,1]
    v_pk_fma_f32 v[248:249], v[24:25], v[188:189], v[248:249] op_sel_hi:[1,0,1] neg_lo:[0,1,0] neg_hi:[0,1,0]
    s_waitcnt lgkmcnt(4)
    v_pk_mul_f32 v[8:9], v[212:213], v[252:253] op_sel_hi:[1,0]
    v_pk_mul_f32 v[24:25], v[212:213], v[252:253] op_sel:[0,1] op_sel_hi:[1,1]
    v_pk_fma_f32 v[8:9], v[104:105], v[250:251], v[8:9] neg_lo:[0,0,1] neg_hi:[0,0,1]
    v_pk_fma_f32 v[24:25], v[104:105], v[248:249], v[24:25] neg_lo:[0,0,1] neg_hi:[0,0,1]
    v_pk_mul_f32 v[250:251], v[10:11], v[188:189] op_sel_hi:[1,0]
    v_pk_mul_f32 v[248:249], v[10:11], v[188:189] op_sel:[0,1] op_sel_hi:[1,1]
    v_pk_fma_f32 v[250:251], v[26:27], v[188:189], v[250:251] op_sel:[0,1,0] op_sel_hi:[1,1,1]
    v_pk_fma_f32 v[248:249], v[26:27], v[188:189], v[248:249] op_sel_hi:[1,0,1] neg_lo:[0,1,0] neg_hi:[0,1,0]
    v_pk_mul_f32 v[10:11], v[214:215], v[252:253] op_sel_hi:[1,0]
    v_pk_mul_f32 v[26:27], v[214:215], v[252:253] op_sel:[0,1] op_sel_hi:[1,1]
    v_pk_fma_f32 v[10:11], v[106:107], v[250:251], v[10:11] neg_lo:[0,0,1] neg_hi:[0,0,1]
    v_pk_fma_f32 v[26:27], v[106:107], v[248:249], v[26:27] neg_lo:[0,0,1] neg_hi:[0,0,1]
    v_pk_mul_f32 v[250:251], v[12:13], v[188:189] op_sel_hi:[1,0]
    buffer_load_dwordx4 v205, s[36:39], s51 offen offset:1024 lds
    v_pk_mul_f32 v[248:249], v[12:13], v[188:189] op_sel:[0,1] op_sel_hi:[1,1]
    v_pk_fma_f32 v[250:251], v[28:29], v[188:189], v[250:251] op_sel:[0,1,0] op_sel_hi:[1,1,1]
    v_pk_fma_f32 v[248:249], v[28:29], v[188:189], v[248:249] op_sel_hi:[1,0,1] neg_lo:[0,1,0] neg_hi:[0,1,0]
    s_waitcnt lgkmcnt(3)
    v_pk_mul_f32 v[12:13], v[216:217], v[252:253] op_sel_hi:[1,0]
    v_pk_mul_f32 v[28:29], v[216:217], v[252:253] op_sel:[0,1] op_sel_hi:[1,1]
    v_pk_fma_f32 v[12:13], v[108:109], v[250:251], v[12:13] neg_lo:[0,0,1] neg_hi:[0,0,1]
    v_pk_fma_f32 v[28:29], v[108:109], v[248:249], v[28:29] neg_lo:[0,0,1] neg_hi:[0,0,1]
    v_pk_mul_f32 v[250:251], v[14:15], v[188:189] op_sel_hi:[1,0]
    v_pk_mul_f32 v[248:249], v[14:15], v[188:189] op_sel:[0,1] op_sel_hi:[1,1]
    v_pk_fma_f32 v[250:251], v[30:31], v[188:189], v[250:251] op_sel:[0,1,0] op_sel_hi:[1,1,1]
    v_pk_fma_f32 v[248:249], v[30:31], v[188:189], v[248:249] op_sel_hi:[1,0,1] neg_lo:[0,1,0] neg_hi:[0,1,0]
    v_pk_mul_f32 v[14:15], v[218:219], v[252:253] op_sel_hi:[1,0]
    v_pk_mul_f32 v[30:31], v[218:219], v[252:253] op_sel:[0,1] op_sel_hi:[1,1]
    v_pk_fma_f32 v[14:15], v[110:111], v[250:251], v[14:15] neg_lo:[0,0,1] neg_hi:[0,0,1]
    v_pk_fma_f32 v[30:31], v[110:111], v[248:249], v[30:31] neg_lo:[0,0,1] neg_hi:[0,0,1]
    v_pk_mul_f32 v[250:251], v[16:17], v[188:189] op_sel_hi:[1,0]
    buffer_load_dwordx4 v204, s[36:39], s51 offen offset:2048 lds
    v_pk_mul_f32 v[248:249], v[16:17], v[188:189] op_sel:[0,1] op_sel_hi:[1,1]
    v_pk_fma_f32 v[250:251], v[32:33], v[188:189], v[250:251] op_sel:[0,1,0] op_sel_hi:[1,1,1]
    v_pk_fma_f32 v[248:249], v[32:33], v[188:189], v[248:249] op_sel_hi:[1,0,1] neg_lo:[0,1,0] neg_hi:[0,1,0]
    s_waitcnt lgkmcnt(2)
    v_pk_mul_f32 v[16:17], v[220:221], v[252:253] op_sel_hi:[1,0]
    v_pk_mul_f32 v[32:33], v[220:221], v[252:253] op_sel:[0,1] op_sel_hi:[1,1]
    v_pk_fma_f32 v[16:17], v[112:113], v[250:251], v[16:17] neg_lo:[0,0,1] neg_hi:[0,0,1]
    v_pk_fma_f32 v[32:33], v[112:113], v[248:249], v[32:33] neg_lo:[0,0,1] neg_hi:[0,0,1]
    v_pk_mul_f32 v[250:251], v[18:19], v[188:189] op_sel_hi:[1,0]
    v_pk_mul_f32 v[248:249], v[18:19], v[188:189] op_sel:[0,1] op_sel_hi:[1,1]
    v_pk_fma_f32 v[250:251], v[34:35], v[188:189], v[250:251] op_sel:[0,1,0] op_sel_hi:[1,1,1]
    v_pk_fma_f32 v[248:249], v[34:35], v[188:189], v[248:249] op_sel_hi:[1,0,1] neg_lo:[0,1,0] neg_hi:[0,1,0]
    v_pk_mul_f32 v[18:19], v[222:223], v[252:253] op_sel_hi:[1,0]
    v_pk_mul_f32 v[34:35], v[222:223], v[252:253] op_sel:[0,1] op_sel_hi:[1,1]
    v_pk_fma_f32 v[18:19], v[114:115], v[250:251], v[18:19] neg_lo:[0,0,1] neg_hi:[0,0,1]
    v_pk_fma_f32 v[34:35], v[114:115], v[248:249], v[34:35] neg_lo:[0,0,1] neg_hi:[0,0,1]
    v_fma_f32 v250, v198, v4, v5
    buffer_load_dwordx4 v203, s[36:39], s51 offen offset:3072 lds
    v_fma_f32 v251, v198, v20, v21
    v_fma_f32 v250, -v199, v20, v250
    v_fma_f32 v251, v199, v4, v251
    v_fma_f32 v248, v198, v250, v6
    v_fma_f32 v249, v198, v251, v22
    v_fma_f32 v248, -v199, v251, v248
    v_fma_f32 v249, v199, v250, v249
    v_fma_f32 v250, v198, v248, v7
    v_fma_f32 v251, v198, v249, v23
    v_fma_f32 v250, -v199, v249, v250
    v_fma_f32 v251, v199, v248, v251
    v_fma_f32 v248, v198, v250, v8
    v_fma_f32 v249, v198, v251, v24
    v_fma_f32 v248, -v199, v251, v248
    v_fma_f32 v249, v199, v250, v249
    v_fma_f32 v250, v198, v248, v9
    v_fma_f32 v251, v198, v249, v25
    s_mul_i32 s51, s49, 28672
    s_add_u32 m0, s44, 8192
    s_add_u32 s51, s51, s45
    s_add_u32 s49, s49, 1
    s_cmp_eq_u32 s49, 14
    s_cselect_b32 s49, 0, s49
    buffer_load_dwordx4 v206, s[36:39], s51 offen offset:0 lds
    v_fma_f32 v250, -v199, v249, v250
    v_fma_f32 v251, v199, v248, v251
    v_fma_f32 v248, v198, v250, v10
    v_fma_f32 v249, v198, v251, v26
    v_fma_f32 v248, -v199, v251, v248
    v_fma_f32 v249, v199, v250, v249
    v_fma_f32 v250, v198, v248, v11
    v_fma_f32 v251, v198, v249, v27
    v_fma_f32 v250, -v199, v249, v250
    v_fma_f32 v251, v199, v248, v251
    v_fma_f32 v248, v198, v250, v12
    v_fma_f32 v249, v198, v251, v28
    v_fma_f32 v248, -v199, v251, v248
    v_fma_f32 v249, v199, v250, v249
    v_fma_f32 v250, v198, v248, v13
    v_fma_f32 v251, v198, v249, v29
    buffer_load_dwordx4 v205, s[36:39], s51 offen offset:1024 lds
    v_fma_f32 v250, -v199, v249, v250
    v_fma_f32 v251, v199, v248, v251
    v_fma_f32 v248, v198, v250, v14
    v_fma_f32 v249, v198, v251, v30
    v_fma_f32 v248, -v199, v251, v248
    v_fma_f32 v249, v199, v250, v249
    v_fma_f32 v250, v198, v248, v15
    v_fma_f32 v251, v198, v249, v31
    v_fma_f32 v250, -v199, v249, v250
    v_fma_f32 v251, v199, v248, v251
    v_fma_f32 v248, v198, v250, v16
    v_fma_f32 v249, v198, v251, v32
    v_fma_f32 v248, -v199, v251, v248
    v_fma_f32 v249, v199, v250, v249
    v_fma_f32 v250, v198, v248, v17
    v_fma_f32 v251, v198, v249, v33
    buffer_load_dwordx4 v204, s[36:39], s51 offen offset:2048 lds
    v_fma_f32 v250, -v199, v249, v250
    v_fma_f32 v251, v199, v248, v251
    v_fma_f32 v248, v198, v250, v18
    v_fma_f32 v249, v198, v251, v34
    v_fma_f32 v248, -v199, v251, v248
    v_fma_f32 v249, v199, v250, v249
    v_fma_f32 v250, v198, v248, v19
    v_fma_f32 v251, v198, v249, v35
    v_fma_f32 v250, -v199, v249, v250
    v_fma_f32 v251, v199, v248, v251
    s_lshl_b32 s84, s3, 9
    s_add_u32 s85, s84, 157184
    v_lshlrev_b32 v243, 8, v3
    v_lshl_add_u32 v243, v2, 3, v243
    v_add_u32 v243, s85, v243
    ds_write_b64 v243, v[250:251] offset:0
    v_lshlrev_b32 v242, 3, v2
    v_add_u32 v243, s85, v242
    v_add_u32 v242, 157184, v242
    buffer_load_dwordx4 v203, s[36:39], s51 offen offset:3072 lds
    s_mul_i32 s51, s49, 28672
    s_add_u32 m0, s44, 12288
    s_add_u32 s51, s51, s45
    s_add_u32 s49, s49, 1
    s_cmp_eq_u32 s49, 14
    s_cselect_b32 s49, 0, s49
    buffer_load_dwordx4 v206, s[36:39], s51 offen offset:0 lds
    buffer_load_dwordx4 v205, s[36:39], s51 offen offset:1024 lds
    s_waitcnt lgkmcnt(0)
    s_barrier
    ds_read_b64 v[240:241], v242 offset:0
    ds_read_b64 v[238:239], v242 offset:256
    ds_read_b64 v[236:237], v242 offset:512
    ds_read_b64 v[234:235], v242 offset:768
    ds_read_b64 v[228:229], v242 offset:1024
    ds_read_b64 v[226:227], v242 offset:1280
    ds_read_b64 v[224:225], v243 offset:0
    buffer_load_dwordx4 v204, s[36:39], s51 offen offset:2048 lds
    buffer_load_dwordx4 v203, s[36:39], s51 offen offset:3072 lds
    v_mov_b32 v174, 0
    v_mov_b32 v175, 0
    s_cmp_gt_u32 s3, 0
    s_cselect_b64 exec, -1, 0
    s_waitcnt lgkmcnt(6)
    v_fma_f32 v244, v196, v174, v240
    v_fma_f32 v245, v196, v175, v241
    v_fma_f32 v244, -v197, v175, v244
    v_fma_f32 v175, v197, v174, v245
    v_mov_b32 v174, v244
    s_cmp_gt_u32 s3, 0
    s_cselect_b64 exec, -1, 0
    s_waitcnt lgkmcnt(5)
    v_fma_f32 v244, v196, v174, v238
    v_fma_f32 v245, v196, v175, v239
    v_fma_f32 v244, -v197, v175, v244
    v_fma_f32 v175, v197, v174, v245
    v_mov_b32 v174, v244
    s_cmp_gt_u32 s3, 1
    s_cselect_b64 exec, -1, 0
    s_waitcnt lgkmcnt(4)
    v_fma_f32 v244, v196, v174, v236
    v_fma_f32 v245, v196, v175, v237
    v_fma_f32 v244, -v197, v175, v244
    v_fma_f32 v175, v197, v174, v245
    v_mov_b32 v174, v244
    s_cmp_gt_u32 s3, 1
    s_cselect_b64 exec, -1, 0
    s_waitcnt lgkmcnt(3)
    v_fma_f32 v244, v196, v174, v234
    v_fma_f32 v245, v196, v175, v235
    v_fma_f32 v244, -v197, v175, v244
    v_fma_f32 v175, v197, v174, v245
    v_mov_b32 v174, v244
    s_cmp_gt_u32 s3, 2
    s_cselect_b64 exec, -1, 0
    s_waitcnt lgkmcnt(2)
    v_fma_f32 v244, v196, v174, v228
    v_fma_f32 v245, v196, v175, v229
    v_fma_f32 v244, -v197, v175, v244
    v_fma_f32 v175, v197, v174, v245
    v_mov_b32 v174, v244
    s_cmp_gt_u32 s3, 2
    s_cselect_b64 exec, -1, 0
    s_waitcnt lgkmcnt(1)
    v_fma_f32 v244, v196, v174, v226
    v_fma_f32 v245, v196, v175, v227
    v_fma_f32 v244, -v197, v175, v244
    v_fma_f32 v175, v197, v174, v245
    v_mov_b32 v174, v244
    s_mov_b32 exec_lo, 0
    s_mov_b32 exec_hi, -1
    s_waitcnt lgkmcnt(0)
    v_fma_f32 v244, v196, v174, v224
    v_fma_f32 v245, v196, v175, v225
    v_fma_f32 v244, -v197, v175, v244
    v_fma_f32 v175, v197, v174, v245
    v_mov_b32 v174, v244
    s_mov_b64 exec, -1
    s_mul_i32 s51, s49, 28672
    s_add_u32 m0, s44, 16384
    s_add_u32 s51, s51, s45
    s_add_u32 s49, s49, 1
    s_cmp_eq_u32 s49, 14
    s_cselect_b32 s49, 0, s49
    buffer_load_dwordx4 v206, s[36:39], s51 offen offset:0 lds
    buffer_load_dwordx4 v205, s[36:39], s51 offen offset:1024 lds
    buffer_load_dwordx4 v204, s[36:39], s51 offen offset:2048 lds
    v_fma_f32 v244, v196, v174, v250
    v_fma_f32 v245, v196, v175, v251
    v_fma_f32 v244, -v197, v175, v244
    v_fma_f32 v117, v197, v174, v245
    v_mov_b32 v116, v244
    v_mov_b32 v118, s96
    v_mov_b32 v119, s96
    v_lshlrev_b32 v243, 4, v2
    v_cmp_eq_u32 vcc, 1, v3
    v_mov_b32 v242, 33554432
    s_lshl_b32 s84, s5, 4
    s_add_u32 s84, s84, s4
    s_lshl_b32 s84, s84, 9
    s_add_u32 s84, s84, 11042816
    v_cndmask_b32 v243, v242, v243, vcc
    s_cmp_eq_u32 s3, 3
    s_cselect_b32 s84, s84, 33554432
    buffer_store_dwordx4 v[116:119], v243, s[28:31], s84 offen sc1
    s_nop 1
    v_lshlrev_b32 v253, 5, v3
    v_add_u32 v253, 157184, v253
    s_lshl_b32 s84, s3, 9
    v_add_u32 v252, s84, v253
    v_lshlrev_b32 v251, 4, v1
    v_mov_b32 v248, 0xbdd2d3e8
    v_mov_b32 v249, 0xc0135761
    s_lshl_b32 s79, s4, 2
    s_add_u32 s79, s79, s3
    s_mul_i32 s79, s79, 112
    s_lshl_b32 s84, s5, 3
    s_add_u32 s79, s79, s84
    s_lshl_b32 s79, s79, 10
    ds_read_b128 v[100:103], v252 offset:4096
    ds_read_b128 v[116:119], v253 offset:6144
    ds_read_b128 v[104:107], v252 offset:4112
    ds_read_b128 v[120:123], v253 offset:6160
    ds_read_b128 v[108:111], v252 offset:4160
    ds_read_b128 v[124:127], v253 offset:6208
    ds_read_b128 v[112:115], v252 offset:4176
    ds_read_b128 v[128:131], v253 offset:6224
    buffer_load_dwordx4 v203, s[36:39], s51 offen offset:3072 lds
    s_mul_i32 s51, s49, 28672
    s_add_u32 m0, s44, 20480
    s_add_u32 s51, s51, s45
    s_add_u32 s49, s49, 1
    s_cmp_eq_u32 s49, 14
    s_cselect_b32 s49, 0, s49
    buffer_load_dwordx4 v206, s[36:39], s51 offen offset:0 lds
    s_waitcnt lgkmcnt(6)
    v_pk_fma_f32 v[116:117], v[100:101], v[254:255], v[116:117] op_sel:[0,1,0] op_sel_hi:[1,1,1] neg_lo:[0,1,0] neg_hi:[0,1,0]
    v_pk_fma_f32 v[118:119], v[102:103], v[254:255], v[118:119] op_sel:[0,1,0] op_sel_hi:[1,1,1] neg_lo:[0,1,0] neg_hi:[0,1,0]
    s_waitcnt lgkmcnt(4)
    v_pk_fma_f32 v[120:121], v[104:105], v[254:255], v[120:121] op_sel:[0,1,0] op_sel_hi:[1,1,1] neg_lo:[0,1,0] neg_hi:[0,1,0]
    v_pk_fma_f32 v[122:123], v[106:107], v[254:255], v[122:123] op_sel:[0,1,0] op_sel_hi:[1,1,1] neg_lo:[0,1,0] neg_hi:[0,1,0]
    s_waitcnt lgkmcnt(2)
    v_pk_fma_f32 v[124:125], v[108:109], v[254:255], v[124:125] op_sel:[0,1,0] op_sel_hi:[1,1,1] neg_lo:[0,1,0] neg_hi:[0,1,0]
    v_pk_fma_f32 v[126:127], v[110:111], v[254:255], v[126:127] op_sel:[0,1,0] op_sel_hi:[1,1,1] neg_lo:[0,1,0] neg_hi:[0,1,0]
    s_waitcnt lgkmcnt(0)
    v_pk_fma_f32 v[128:129], v[112:113], v[254:255], v[128:129] op_sel:[0,1,0] op_sel_hi:[1,1,1] neg_lo:[0,1,0] neg_hi:[0,1,0]
    v_pk_fma_f32 v[130:131], v[114:115], v[254:255], v[130:131] op_sel:[0,1,0] op_sel_hi:[1,1,1] neg_lo:[0,1,0] neg_hi:[0,1,0]
    v_pk_fma_f32 v[36:37], v[36:37], v[254:255], v[116:117] op_sel_hi:[1,0,1]
    buffer_load_dwordx4 v205, s[36:39], s51 offen offset:1024 lds
    v_pk_fma_f32 v[38:39], v[38:39], v[254:255], v[118:119] op_sel_hi:[1,0,1]
    v_pk_fma_f32 v[40:41], v[40:41], v[254:255], v[120:121] op_sel_hi:[1,0,1]
    v_pk_fma_f32 v[42:43], v[42:43], v[254:255], v[122:123] op_sel_hi:[1,0,1]
    v_pk_fma_f32 v[44:45], v[44:45], v[254:255], v[124:125] op_sel_hi:[1,0,1]
    v_pk_fma_f32 v[46:47], v[46:47], v[254:255], v[126:127] op_sel_hi:[1,0,1]
    v_pk_fma_f32 v[48:49], v[48:49], v[254:255], v[128:129] op_sel_hi:[1,0,1]
    v_pk_fma_f32 v[50:51], v[50:51], v[254:255], v[130:131] op_sel_hi:[1,0,1]
    v_pk_mul_f32 v[132:133], v[36:37], v[36:37]
    v_pk_mul_f32 v[134:135], v[38:39], v[38:39]
    v_pk_mul_f32 v[136:137], v[40:41], v[40:41]
    v_pk_mul_f32 v[138:139], v[42:43], v[42:43]
    v_pk_mul_f32 v[140:141], v[44:45], v[44:45]
    v_pk_mul_f32 v[142:143], v[46:47], v[46:47]
    v_pk_mul_f32 v[144:145], v[48:49], v[48:49]
    v_pk_mul_f32 v[146:147], v[50:51], v[50:51]
    v_pk_fma_f32 v[132:133], v[132:133], v[248:249], v[248:249] op_sel:[0,0,1] op_sel_hi:[1,0,1]
    buffer_load_dwordx4 v204, s[36:39], s51 offen offset:2048 lds
    v_pk_fma_f32 v[134:135], v[134:135], v[248:249], v[248:249] op_sel:[0,0,1] op_sel_hi:[1,0,1]
    v_pk_fma_f32 v[136:137], v[136:137], v[248:249], v[248:249] op_sel:[0,0,1] op_sel_hi:[1,0,1]
    v_pk_fma_f32 v[138:139], v[138:139], v[248:249], v[248:249] op_sel:[0,0,1] op_sel_hi:[1,0,1]
    v_pk_fma_f32 v[140:141], v[140:141], v[248:249], v[248:249] op_sel:[0,0,1] op_sel_hi:[1,0,1]
    v_pk_fma_f32 v[142:143], v[142:143], v[248:249], v[248:249] op_sel:[0,0,1] op_sel_hi:[1,0,1]
    v_pk_fma_f32 v[144:145], v[144:145], v[248:249], v[248:249] op_sel:[0,0,1] op_sel_hi:[1,0,1]
    v_pk_fma_f32 v[146:147], v[146:147], v[248:249], v[248:249] op_sel:[0,0,1] op_sel_hi:[1,0,1]
    v_pk_mul_f32 v[132:133], v[132:133], v[36:37]
    v_pk_mul_f32 v[134:135], v[134:135], v[38:39]
    v_pk_mul_f32 v[136:137], v[136:137], v[40:41]
    v_pk_mul_f32 v[138:139], v[138:139], v[42:43]
    v_pk_mul_f32 v[140:141], v[140:141], v[44:45]
    v_pk_mul_f32 v[142:143], v[142:143], v[46:47]
    v_pk_mul_f32 v[144:145], v[144:145], v[48:49]
    v_pk_mul_f32 v[146:147], v[146:147], v[50:51]
    v_exp_f32 v132, v132
    buffer_load_dwordx4 v203, s[36:39], s51 offen offset:3072 lds
    v_exp_f32 v133, v133
    v_exp_f32 v134, v134
    v_exp_f32 v135, v135
    v_exp_f32 v136, v136
    v_exp_f32 v137, v137
    v_exp_f32 v138, v138
    v_exp_f32 v139, v139
    v_exp_f32 v140, v140
    s_mul_i32 s51, s49, 28672
    s_add_u32 m0, s44, 24576
    s_add_u32 s51, s51, s45
    s_add_u32 s49, s49, 1
    s_cmp_eq_u32 s49, 14
    s_cselect_b32 s49, 0, s49
    buffer_load_dwordx4 v206, s[36:39], s51 offen offset:0 lds
    v_exp_f32 v141, v141
    v_exp_f32 v142, v142
    v_exp_f32 v143, v143
    v_exp_f32 v144, v144
    v_exp_f32 v145, v145
    v_exp_f32 v146, v146
    v_exp_f32 v147, v147
    v_pk_add_f32 v[132:133], v[132:133], 1.0 op_sel_hi:[1,0]
    v_pk_add_f32 v[134:135], v[134:135], 1.0 op_sel_hi:[1,0]
    buffer_load_dwordx4 v205, s[36:39], s51 offen offset:1024 lds
    v_pk_add_f32 v[136:137], v[136:137], 1.0 op_sel_hi:[1,0]
    v_pk_add_f32 v[138:139], v[138:139], 1.0 op_sel_hi:[1,0]
    v_pk_add_f32 v[140:141], v[140:141], 1.0 op_sel_hi:[1,0]
    v_pk_add_f32 v[142:143], v[142:143], 1.0 op_sel_hi:[1,0]
    v_pk_add_f32 v[144:145], v[144:145], 1.0 op_sel_hi:[1,0]
    v_pk_add_f32 v[146:147], v[146:147], 1.0 op_sel_hi:[1,0]
    v_rcp_f32 v132, v132
    v_rcp_f32 v133, v133
    v_rcp_f32 v134, v134
    v_rcp_f32 v135, v135
    v_rcp_f32 v136, v136
    buffer_load_dwordx4 v204, s[36:39], s51 offen offset:2048 lds
    v_rcp_f32 v137, v137
    v_rcp_f32 v138, v138
    v_rcp_f32 v139, v139
    v_rcp_f32 v140, v140
    v_rcp_f32 v141, v141
    v_rcp_f32 v142, v142
    v_rcp_f32 v143, v143
    v_rcp_f32 v144, v144
    buffer_load_dwordx4 v203, s[36:39], s51 offen offset:3072 lds
    v_rcp_f32 v145, v145
    v_rcp_f32 v146, v146
    v_rcp_f32 v147, v147
    v_pk_mul_f32 v[132:133], v[132:133], v[36:37]
    v_pk_mul_f32 v[134:135], v[134:135], v[38:39]
    v_pk_mul_f32 v[136:137], v[136:137], v[40:41]
    v_pk_mul_f32 v[138:139], v[138:139], v[42:43]
    v_pk_mul_f32 v[140:141], v[140:141], v[44:45]
    v_pk_mul_f32 v[142:143], v[142:143], v[46:47]
    v_pk_mul_f32 v[144:145], v[144:145], v[48:49]
    v_pk_mul_f32 v[146:147], v[146:147], v[50:51]
    v_cvt_pk_bf16_f32 v148, v132, v133
    v_cvt_pk_bf16_f32 v149, v134, v135
    v_cvt_pk_bf16_f32 v150, v136, v137
    s_mul_i32 s51, s49, 28672
    s_add_u32 m0, s44, 28672
    s_add_u32 s51, s51, s45
    s_add_u32 s49, s49, 1
    s_cmp_eq_u32 s49, 14
    s_cselect_b32 s49, 0, s49
    buffer_load_dwordx4 v206, s[36:39], s51 offen offset:0 lds
    v_cvt_pk_bf16_f32 v151, v138, v139
    v_cvt_pk_bf16_f32 v152, v140, v141
    v_cvt_pk_bf16_f32 v153, v142, v143
    v_cvt_pk_bf16_f32 v154, v144, v145
    v_cvt_pk_bf16_f32 v155, v146, v147
    ds_read_b128 v[100:103], v252 offset:4224
    ds_read_b128 v[116:119], v253 offset:6272
    ds_read_b128 v[104:107], v252 offset:4240
    ds_read_b128 v[120:123], v253 offset:6288
    ds_read_b128 v[108:111], v252 offset:4288
    ds_read_b128 v[124:127], v253 offset:6336
    ds_read_b128 v[112:115], v252 offset:4304
    ds_read_b128 v[128:131], v253 offset:6352
    buffer_load_dwordx4 v205, s[36:39], s51 offen offset:1024 lds
    s_waitcnt lgkmcnt(6)
    v_pk_fma_f32 v[116:117], v[100:101], v[254:255], v[116:117] op_sel:[0,1,0] op_sel_hi:[1,1,1] neg_lo:[0,1,0] neg_hi:[0,1,0]
    v_pk_fma_f32 v[118:119], v[102:103], v[254:255], v[118:119] op_sel:[0,1,0] op_sel_hi:[1,1,1] neg_lo:[0,1,0] neg_hi:[0,1,0]
    buffer_load_dwordx4 v204, s[36:39], s51 offen offset:2048 lds
    s_waitcnt lgkmcnt(4)
    v_pk_fma_f32 v[120:121], v[104:105], v[254:255], v[120:121] op_sel:[0,1,0] op_sel_hi:[1,1,1] neg_lo:[0,1,0] neg_hi:[0,1,0]
    v_pk_fma_f32 v[122:123], v[106:107], v[254:255], v[122:123] op_sel:[0,1,0] op_sel_hi:[1,1,1] neg_lo:[0,1,0] neg_hi:[0,1,0]
    s_waitcnt lgkmcnt(2)
    v_pk_fma_f32 v[124:125], v[108:109], v[254:255], v[124:125] op_sel:[0,1,0] op_sel_hi:[1,1,1] neg_lo:[0,1,0] neg_hi:[0,1,0]
    v_pk_fma_f32 v[126:127], v[110:111], v[254:255], v[126:127] op_sel:[0,1,0] op_sel_hi:[1,1,1] neg_lo:[0,1,0] neg_hi:[0,1,0]
    s_waitcnt lgkmcnt(0)
    v_pk_fma_f32 v[128:129], v[112:113], v[254:255], v[128:129] op_sel:[0,1,0] op_sel_hi:[1,1,1] neg_lo:[0,1,0] neg_hi:[0,1,0]
    v_pk_fma_f32 v[130:131], v[114:115], v[254:255], v[130:131] op_sel:[0,1,0] op_sel_hi:[1,1,1] neg_lo:[0,1,0] neg_hi:[0,1,0]
    v_pk_fma_f32 v[52:53], v[52:53], v[254:255], v[116:117] op_sel_hi:[1,0,1]
    v_pk_fma_f32 v[54:55], v[54:55], v[254:255], v[118:119] op_sel_hi:[1,0,1]
    v_pk_fma_f32 v[56:57], v[56:57], v[254:255], v[120:121] op_sel_hi:[1,0,1]
    v_pk_fma_f32 v[58:59], v[58:59], v[254:255], v[122:123] op_sel_hi:[1,0,1]
    v_pk_fma_f32 v[60:61], v[60:61], v[254:255], v[124:125] op_sel_hi:[1,0,1]
    v_pk_fma_f32 v[62:63], v[62:63], v[254:255], v[126:127] op_sel_hi:[1,0,1]
    v_pk_fma_f32 v[64:65], v[64:65], v[254:255], v[128:129] op_sel_hi:[1,0,1]
    v_pk_fma_f32 v[66:67], v[66:67], v[254:255], v[130:131] op_sel_hi:[1,0,1]
    v_pk_mul_f32 v[132:133], v[52:53], v[52:53]
    v_pk_mul_f32 v[134:135], v[54:55], v[54:55]
    buffer_load_dwordx4 v203, s[36:39], s51 offen offset:3072 lds
    v_pk_mul_f32 v[136:137], v[56:57], v[56:57]
    v_pk_mul_f32 v[138:139], v[58:59], v[58:59]
    v_pk_mul_f32 v[140:141], v[60:61], v[60:61]
    v_pk_mul_f32 v[142:143], v[62:63], v[62:63]
    v_pk_mul_f32 v[144:145], v[64:65], v[64:65]
    v_pk_mul_f32 v[146:147], v[66:67], v[66:67]
    v_pk_fma_f32 v[132:133], v[132:133], v[248:249], v[248:249] op_sel:[0,0,1] op_sel_hi:[1,0,1]
    v_pk_fma_f32 v[134:135], v[134:135], v[248:249], v[248:249] op_sel:[0,0,1] op_sel_hi:[1,0,1]
    v_pk_fma_f32 v[136:137], v[136:137], v[248:249], v[248:249] op_sel:[0,0,1] op_sel_hi:[1,0,1]
    v_pk_fma_f32 v[138:139], v[138:139], v[248:249], v[248:249] op_sel:[0,0,1] op_sel_hi:[1,0,1]
    v_pk_fma_f32 v[140:141], v[140:141], v[248:249], v[248:249] op_sel:[0,0,1] op_sel_hi:[1,0,1]
    v_pk_fma_f32 v[142:143], v[142:143], v[248:249], v[248:249] op_sel:[0,0,1] op_sel_hi:[1,0,1]
    v_pk_fma_f32 v[144:145], v[144:145], v[248:249], v[248:249] op_sel:[0,0,1] op_sel_hi:[1,0,1]
    v_pk_fma_f32 v[146:147], v[146:147], v[248:249], v[248:249] op_sel:[0,0,1] op_sel_hi:[1,0,1]
    v_pk_mul_f32 v[132:133], v[132:133], v[52:53]
    v_pk_mul_f32 v[134:135], v[134:135], v[54:55]
    v_pk_mul_f32 v[136:137], v[136:137], v[56:57]
    s_mul_i32 s51, s49, 28672
    s_add_u32 m0, s44, 32768
    s_add_u32 s51, s51, s45
    s_add_u32 s49, s49, 1
    s_cmp_eq_u32 s49, 14
    s_cselect_b32 s49, 0, s49
    buffer_load_dwordx4 v206, s[36:39], s51 offen offset:0 lds
    v_pk_mul_f32 v[138:139], v[138:139], v[58:59]
    v_pk_mul_f32 v[140:141], v[140:141], v[60:61]
    v_pk_mul_f32 v[142:143], v[142:143], v[62:63]
    v_pk_mul_f32 v[144:145], v[144:145], v[64:65]
    v_pk_mul_f32 v[146:147], v[146:147], v[66:67]
    v_exp_f32 v132, v132
    v_exp_f32 v133, v133
    v_exp_f32 v134, v134
    v_exp_f32 v135, v135
    v_exp_f32 v136, v136
    v_exp_f32 v137, v137
    buffer_load_dwordx4 v205, s[36:39], s51 offen offset:1024 lds
    v_exp_f32 v138, v138
    v_exp_f32 v139, v139
    v_exp_f32 v140, v140
    v_exp_f32 v141, v141
    v_exp_f32 v142, v142
    v_exp_f32 v143, v143
    v_exp_f32 v144, v144
    v_exp_f32 v145, v145
    buffer_load_dwordx4 v204, s[36:39], s51 offen offset:2048 lds
    v_exp_f32 v146, v146
    v_exp_f32 v147, v147
    v_pk_add_f32 v[132:133], v[132:133], 1.0 op_sel_hi:[1,0]
    v_pk_add_f32 v[134:135], v[134:135], 1.0 op_sel_hi:[1,0]
    v_pk_add_f32 v[136:137], v[136:137], 1.0 op_sel_hi:[1,0]
    v_pk_add_f32 v[138:139], v[138:139], 1.0 op_sel_hi:[1,0]
    v_pk_add_f32 v[140:141], v[140:141], 1.0 op_sel_hi:[1,0]
    v_pk_add_f32 v[142:143], v[142:143], 1.0 op_sel_hi:[1,0]
    v_pk_add_f32 v[144:145], v[144:145], 1.0 op_sel_hi:[1,0]
    v_pk_add_f32 v[146:147], v[146:147], 1.0 op_sel_hi:[1,0]
    v_rcp_f32 v132, v132
    v_rcp_f32 v133, v133
    buffer_load_dwordx4 v203, s[36:39], s51 offen offset:3072 lds
    v_rcp_f32 v134, v134
    v_rcp_f32 v135, v135
    v_rcp_f32 v136, v136
    v_rcp_f32 v137, v137
    v_rcp_f32 v138, v138
    v_rcp_f32 v139, v139
    v_rcp_f32 v140, v140
    v_rcp_f32 v141, v141
    s_waitcnt vmcnt(33)
    ds_read_b64_tr_b16 a[0:1], v185 offset:0
    ds_read_b64_tr_b16 a[2:3], v185 offset:512
    ds_read_b64_tr_b16 a[4:5], v184 offset:0
    ds_read_b64_tr_b16 a[6:7], v184 offset:512
    ds_read_b64_tr_b16 a[8:9], v185 offset:2048
    ds_read_b64_tr_b16 a[10:11], v185 offset:2560
    ds_read_b64_tr_b16 a[12:13], v184 offset:2048
    ds_read_b64_tr_b16 a[14:15], v184 offset:2560
    v_rcp_f32 v142, v142
    v_rcp_f32 v143, v143
    v_rcp_f32 v144, v144
    v_rcp_f32 v145, v145
    v_rcp_f32 v146, v146
    v_rcp_f32 v147, v147
    v_pk_mul_f32 v[132:133], v[132:133], v[52:53]
    v_pk_mul_f32 v[134:135], v[134:135], v[54:55]
    v_pk_mul_f32 v[136:137], v[136:137], v[56:57]
    v_pk_mul_f32 v[138:139], v[138:139], v[58:59]
    s_waitcnt lgkmcnt(0)
    s_mul_i32 s51, s49, 28672
    s_add_u32 m0, s44, 0
    s_add_u32 s51, s51, s45
    s_add_u32 s49, s49, 1
    s_cmp_eq_u32 s49, 14
    s_cselect_b32 s49, 0, s49
    buffer_load_dwordx4 v206, s[36:39], s51 offen offset:0 lds
    v_pk_mul_f32 v[140:141], v[140:141], v[60:61]
    v_pk_mul_f32 v[142:143], v[142:143], v[62:63]
    v_pk_mul_f32 v[144:145], v[144:145], v[64:65]
    v_pk_mul_f32 v[146:147], v[146:147], v[66:67]
    v_cvt_pk_bf16_f32 v164, v132, v133
    v_cvt_pk_bf16_f32 v165, v134, v135
    v_cvt_pk_bf16_f32 v166, v136, v137
    v_cvt_pk_bf16_f32 v167, v138, v139
    v_cvt_pk_bf16_f32 v168, v140, v141
    v_cvt_pk_bf16_f32 v169, v142, v143
    v_cvt_pk_bf16_f32 v170, v144, v145
    v_cvt_pk_bf16_f32 v171, v146, v147
    s_barrier
    ds_read_b128 v[100:103], v252 offset:4352
    ds_read_b128 v[116:119], v253 offset:6400
    ds_read_b128 v[104:107], v252 offset:4368
    ds_read_b128 v[120:123], v253 offset:6416
    ds_read_b128 v[108:111], v252 offset:4416
    ds_read_b128 v[124:127], v253 offset:6464
    ds_read_b128 v[112:115], v252 offset:4432
    ds_read_b128 v[128:131], v253 offset:6480
    buffer_load_dwordx4 v205, s[36:39], s51 offen offset:1024 lds
    buffer_load_dwordx4 v204, s[36:39], s51 offen offset:2048 lds
    s_waitcnt lgkmcnt(6)
    v_pk_fma_f32 v[116:117], v[100:101], v[254:255], v[116:117] op_sel:[0,1,0] op_sel_hi:[1,1,1] neg_lo:[0,1,0] neg_hi:[0,1,0]
    v_pk_fma_f32 v[118:119], v[102:103], v[254:255], v[118:119] op_sel:[0,1,0] op_sel_hi:[1,1,1] neg_lo:[0,1,0] neg_hi:[0,1,0]
    s_waitcnt lgkmcnt(4)
    v_pk_fma_f32 v[120:121], v[104:105], v[254:255], v[120:121] op_sel:[0,1,0] op_sel_hi:[1,1,1] neg_lo:[0,1,0] neg_hi:[0,1,0]
    v_pk_fma_f32 v[122:123], v[106:107], v[254:255], v[122:123] op_sel:[0,1,0] op_sel_hi:[1,1,1] neg_lo:[0,1,0] neg_hi:[0,1,0]
    s_waitcnt lgkmcnt(2)
    v_pk_fma_f32 v[124:125], v[108:109], v[254:255], v[124:125] op_sel:[0,1,0] op_sel_hi:[1,1,1] neg_lo:[0,1,0] neg_hi:[0,1,0]
    v_pk_fma_f32 v[126:127], v[110:111], v[254:255], v[126:127] op_sel:[0,1,0] op_sel_hi:[1,1,1] neg_lo:[0,1,0] neg_hi:[0,1,0]
    s_waitcnt lgkmcnt(0)
    v_pk_fma_f32 v[128:129], v[112:113], v[254:255], v[128:129] op_sel:[0,1,0] op_sel_hi:[1,1,1] neg_lo:[0,1,0] neg_hi:[0,1,0]
    v_pk_fma_f32 v[130:131], v[114:115], v[254:255], v[130:131] op_sel:[0,1,0] op_sel_hi:[1,1,1] neg_lo:[0,1,0] neg_hi:[0,1,0]
    v_pk_fma_f32 v[68:69], v[68:69], v[254:255], v[116:117] op_sel_hi:[1,0,1]
    v_pk_fma_f32 v[70:71], v[70:71], v[254:255], v[118:119] op_sel_hi:[1,0,1]
    v_pk_fma_f32 v[72:73], v[72:73], v[254:255], v[120:121] op_sel_hi:[1,0,1]
    v_pk_fma_f32 v[74:75], v[74:75], v[254:255], v[122:123] op_sel_hi:[1,0,1]
    buffer_load_dwordx4 v203, s[36:39], s51 offen offset:3072 lds
    v_pk_fma_f32 v[76:77], v[76:77], v[254:255], v[124:125] op_sel_hi:[1,0,1]
    v_pk_fma_f32 v[78:79], v[78:79], v[254:255], v[126:127] op_sel_hi:[1,0,1]
    v_pk_fma_f32 v[80:81], v[80:81], v[254:255], v[128:129] op_sel_hi:[1,0,1]
    v_pk_fma_f32 v[82:83], v[82:83], v[254:255], v[130:131] op_sel_hi:[1,0,1]
    v_pk_mul_f32 v[132:133], v[68:69], v[68:69]
    v_pk_mul_f32 v[134:135], v[70:71], v[70:71]
    v_pk_mul_f32 v[136:137], v[72:73], v[72:73]
    v_pk_mul_f32 v[138:139], v[74:75], v[74:75]
    v_pk_mul_f32 v[140:141], v[76:77], v[76:77]
    v_pk_mul_f32 v[142:143], v[78:79], v[78:79]
    v_pk_mul_f32 v[144:145], v[80:81], v[80:81]
    v_pk_mul_f32 v[146:147], v[82:83], v[82:83]
    v_pk_fma_f32 v[132:133], v[132:133], v[248:249], v[248:249] op_sel:[0,0,1] op_sel_hi:[1,0,1]
    v_pk_fma_f32 v[134:135], v[134:135], v[248:249], v[248:249] op_sel:[0,0,1] op_sel_hi:[1,0,1]
    v_pk_fma_f32 v[136:137], v[136:137], v[248:249], v[248:249] op_sel:[0,0,1] op_sel_hi:[1,0,1]
    v_pk_fma_f32 v[138:139], v[138:139], v[248:249], v[248:249] op_sel:[0,0,1] op_sel_hi:[1,0,1]
    s_waitcnt vmcnt(33)
    ds_read_b64_tr_b16 a[16:17], v185 offset:4096
    ds_read_b64_tr_b16 a[18:19], v185 offset:4608
    ds_read_b64_tr_b16 a[20:21], v184 offset:4096
    ds_read_b64_tr_b16 a[22:23], v184 offset:4608
    ds_read_b64_tr_b16 a[24:25], v185 offset:6144
    ds_read_b64_tr_b16 a[26:27], v185 offset:6656
    ds_read_b64_tr_b16 a[28:29], v184 offset:6144
    ds_read_b64_tr_b16 a[30:31], v184 offset:6656
    v_pk_fma_f32 v[140:141], v[140:141], v[248:249], v[248:249] op_sel:[0,0,1] op_sel_hi:[1,0,1]
    v_pk_fma_f32 v[142:143], v[142:143], v[248:249], v[248:249] op_sel:[0,0,1] op_sel_hi:[1,0,1]
    v_pk_fma_f32 v[144:145], v[144:145], v[248:249], v[248:249] op_sel:[0,0,1] op_sel_hi:[1,0,1]
    v_pk_fma_f32 v[146:147], v[146:147], v[248:249], v[248:249] op_sel:[0,0,1] op_sel_hi:[1,0,1]
    v_pk_mul_f32 v[132:133], v[132:133], v[68:69]
    v_pk_mul_f32 v[134:135], v[134:135], v[70:71]
    v_pk_mul_f32 v[136:137], v[136:137], v[72:73]
    v_pk_mul_f32 v[138:139], v[138:139], v[74:75]
    v_pk_mul_f32 v[140:141], v[140:141], v[76:77]
    v_pk_mul_f32 v[142:143], v[142:143], v[78:79]
    v_pk_mul_f32 v[144:145], v[144:145], v[80:81]
    v_pk_mul_f32 v[146:147], v[146:147], v[82:83]
    v_exp_f32 v132, v132
    v_exp_f32 v133, v133
    s_waitcnt lgkmcnt(0)
    s_mul_i32 s51, s49, 28672
    s_add_u32 m0, s44, 4096
    s_add_u32 s51, s51, s45
    s_add_u32 s49, s49, 1
    s_cmp_eq_u32 s49, 14
    s_cselect_b32 s49, 0, s49
    buffer_load_dwordx4 v206, s[36:39], s51 offen offset:0 lds
    v_exp_f32 v134, v134
    v_exp_f32 v135, v135
    v_exp_f32 v136, v136
    v_exp_f32 v137, v137
    v_exp_f32 v138, v138
    v_exp_f32 v139, v139
    v_exp_f32 v140, v140
    v_exp_f32 v141, v141
    buffer_load_dwordx4 v205, s[36:39], s51 offen offset:1024 lds
    v_exp_f32 v142, v142
    v_exp_f32 v143, v143
    v_exp_f32 v144, v144
    v_exp_f32 v145, v145
    v_exp_f32 v146, v146
    v_exp_f32 v147, v147
    v_pk_add_f32 v[132:133], v[132:133], 1.0 op_sel_hi:[1,0]
    v_pk_add_f32 v[134:135], v[134:135], 1.0 op_sel_hi:[1,0]
    v_pk_add_f32 v[136:137], v[136:137], 1.0 op_sel_hi:[1,0]
    v_pk_add_f32 v[138:139], v[138:139], 1.0 op_sel_hi:[1,0]
    v_pk_add_f32 v[140:141], v[140:141], 1.0 op_sel_hi:[1,0]
    buffer_load_dwordx4 v204, s[36:39], s51 offen offset:2048 lds
    v_pk_add_f32 v[142:143], v[142:143], 1.0 op_sel_hi:[1,0]
    v_pk_add_f32 v[144:145], v[144:145], 1.0 op_sel_hi:[1,0]
    v_pk_add_f32 v[146:147], v[146:147], 1.0 op_sel_hi:[1,0]
    v_rcp_f32 v132, v132
    v_rcp_f32 v133, v133
    v_rcp_f32 v134, v134
    v_rcp_f32 v135, v135
    v_rcp_f32 v136, v136
    v_rcp_f32 v137, v137
    v_rcp_f32 v138, v138
    buffer_load_dwordx4 v203, s[36:39], s51 offen offset:3072 lds
    v_rcp_f32 v139, v139
    v_rcp_f32 v140, v140
    v_rcp_f32 v141, v141
    v_rcp_f32 v142, v142
    v_rcp_f32 v143, v143
    v_rcp_f32 v144, v144
    v_rcp_f32 v145, v145
    v_rcp_f32 v146, v146
    s_waitcnt vmcnt(33)
    ds_read_b64_tr_b16 a[32:33], v185 offset:8192
    ds_read_b64_tr_b16 a[34:35], v185 offset:8704
    ds_read_b64_tr_b16 a[36:37], v184 offset:8192
    ds_read_b64_tr_b16 a[38:39], v184 offset:8704
    ds_read_b64_tr_b16 a[40:41], v185 offset:10240
    ds_read_b64_tr_b16 a[42:43], v185 offset:10752
    ds_read_b64_tr_b16 a[44:45], v184 offset:10240
    ds_read_b64_tr_b16 a[46:47], v184 offset:10752
    v_rcp_f32 v147, v147
    v_pk_mul_f32 v[132:133], v[132:133], v[68:69]
    v_pk_mul_f32 v[134:135], v[134:135], v[70:71]
    v_pk_mul_f32 v[136:137], v[136:137], v[72:73]
    v_pk_mul_f32 v[138:139], v[138:139], v[74:75]
    v_pk_mul_f32 v[140:141], v[140:141], v[76:77]
    v_pk_mul_f32 v[142:143], v[142:143], v[78:79]
    v_pk_mul_f32 v[144:145], v[144:145], v[80:81]
    v_pk_mul_f32 v[146:147], v[146:147], v[82:83]
    v_cvt_pk_bf16_f32 v208, v132, v133
    v_cvt_pk_bf16_f32 v209, v134, v135
    v_cvt_pk_bf16_f32 v210, v136, v137
    v_cvt_pk_bf16_f32 v211, v138, v139
    v_cvt_pk_bf16_f32 v212, v140, v141
    s_waitcnt lgkmcnt(0)
    s_mul_i32 s51, s49, 28672
    s_add_u32 m0, s44, 8192
    s_add_u32 s51, s51, s45
    s_add_u32 s49, s49, 1
    s_cmp_eq_u32 s49, 14
    s_cselect_b32 s49, 0, s49
    buffer_load_dwordx4 v206, s[36:39], s51 offen offset:0 lds
    v_cvt_pk_bf16_f32 v213, v142, v143
    v_cvt_pk_bf16_f32 v214, v144, v145
    v_cvt_pk_bf16_f32 v215, v146, v147
    v_lshlrev_b32 v250, 9, v3
    v_lshl_add_u32 v250, v2, 4, v250
    s_lshl_b32 s85, s5, 13
    s_lshl_b32 s84, s3, 11
    s_add_u32 s85, s85, s84
    s_add_u32 s85, s85, 11042816
    buffer_load_dwordx4 v[36:39], v250, s[28:31], s85 offen offset:0 sc1
    buffer_load_dwordx4 v[40:43], v250, s[28:31], s85 offen offset:1024 sc1
    ds_read_b128 v[100:103], v252 offset:4480
    ds_read_b128 v[116:119], v253 offset:6528
    ds_read_b128 v[104:107], v252 offset:4496
    ds_read_b128 v[120:123], v253 offset:6544
    ds_read_b128 v[108:111], v252 offset:4544
    ds_read_b128 v[124:127], v253 offset:6592
    ds_read_b128 v[112:115], v252 offset:4560
    ds_read_b128 v[128:131], v253 offset:6608
    buffer_load_dwordx4 v205, s[36:39], s51 offen offset:1024 lds
    s_waitcnt lgkmcnt(6)
    v_pk_fma_f32 v[116:117], v[100:101], v[254:255], v[116:117] op_sel:[0,1,0] op_sel_hi:[1,1,1] neg_lo:[0,1,0] neg_hi:[0,1,0]
    v_pk_fma_f32 v[118:119], v[102:103], v[254:255], v[118:119] op_sel:[0,1,0] op_sel_hi:[1,1,1] neg_lo:[0,1,0] neg_hi:[0,1,0]
    s_waitcnt lgkmcnt(4)
    v_pk_fma_f32 v[120:121], v[104:105], v[254:255], v[120:121] op_sel:[0,1,0] op_sel_hi:[1,1,1] neg_lo:[0,1,0] neg_hi:[0,1,0]
    v_pk_fma_f32 v[122:123], v[106:107], v[254:255], v[122:123] op_sel:[0,1,0] op_sel_hi:[1,1,1] neg_lo:[0,1,0] neg_hi:[0,1,0]
    s_waitcnt lgkmcnt(2)
    v_pk_fma_f32 v[124:125], v[108:109], v[254:255], v[124:125] op_sel:[0,1,0] op_sel_hi:[1,1,1] neg_lo:[0,1,0] neg_hi:[0,1,0]
    buffer_load_dwordx4 v204, s[36:39], s51 offen offset:2048 lds
    v_pk_fma_f32 v[126:127], v[110:111], v[254:255], v[126:127] op_sel:[0,1,0] op_sel_hi:[1,1,1] neg_lo:[0,1,0] neg_hi:[0,1,0]
    s_waitcnt lgkmcnt(0)
    v_pk_fma_f32 v[128:129], v[112:113], v[254:255], v[128:129] op_sel:[0,1,0] op_sel_hi:[1,1,1] neg_lo:[0,1,0] neg_hi:[0,1,0]
    v_pk_fma_f32 v[130:131], v[114:115], v[254:255], v[130:131] op_sel:[0,1,0] op_sel_hi:[1,1,1] neg_lo:[0,1,0] neg_hi:[0,1,0]
    v_pk_fma_f32 v[84:85], v[84:85], v[254:255], v[116:117] op_sel_hi:[1,0,1]
    v_pk_fma_f32 v[86:87], v[86:87], v[254:255], v[118:119] op_sel_hi:[1,0,1]
    v_pk_fma_f32 v[88:89], v[88:89], v[254:255], v[120:121] op_sel_hi:[1,0,1]
    v_pk_fma_f32 v[90:91], v[90:91], v[254:255], v[122:123] op_sel_hi:[1,0,1]
    v_pk_fma_f32 v[92:93], v[92:93], v[254:255], v[124:125] op_sel_hi:[1,0,1]
    v_pk_fma_f32 v[94:95], v[94:95], v[254:255], v[126:127] op_sel_hi:[1,0,1]
    v_pk_fma_f32 v[96:97], v[96:97], v[254:255], v[128:129] op_sel_hi:[1,0,1]
    v_pk_fma_f32 v[98:99], v[98:99], v[254:255], v[130:131] op_sel_hi:[1,0,1]
    v_pk_mul_f32 v[132:133], v[84:85], v[84:85]
    v_pk_mul_f32 v[134:135], v[86:87], v[86:87]
    v_pk_mul_f32 v[136:137], v[88:89], v[88:89]
    v_pk_mul_f32 v[138:139], v[90:91], v[90:91]
    v_pk_mul_f32 v[140:141], v[92:93], v[92:93]
    buffer_load_dwordx4 v203, s[36:39], s51 offen offset:3072 lds
    v_pk_mul_f32 v[142:143], v[94:95], v[94:95]
    v_pk_mul_f32 v[144:145], v[96:97], v[96:97]
    v_pk_mul_f32 v[146:147], v[98:99], v[98:99]
    v_pk_fma_f32 v[132:133], v[132:133], v[248:249], v[248:249] op_sel:[0,0,1] op_sel_hi:[1,0,1]
    v_pk_fma_f32 v[134:135], v[134:135], v[248:249], v[248:249] op_sel:[0,0,1] op_sel_hi:[1,0,1]
    v_pk_fma_f32 v[136:137], v[136:137], v[248:249], v[248:249] op_sel:[0,0,1] op_sel_hi:[1,0,1]
    v_pk_fma_f32 v[138:139], v[138:139], v[248:249], v[248:249] op_sel:[0,0,1] op_sel_hi:[1,0,1]
    v_pk_fma_f32 v[140:141], v[140:141], v[248:249], v[248:249] op_sel:[0,0,1] op_sel_hi:[1,0,1]
    v_pk_fma_f32 v[142:143], v[142:143], v[248:249], v[248:249] op_sel:[0,0,1] op_sel_hi:[1,0,1]
    v_pk_fma_f32 v[144:145], v[144:145], v[248:249], v[248:249] op_sel:[0,0,1] op_sel_hi:[1,0,1]
    v_pk_fma_f32 v[146:147], v[146:147], v[248:249], v[248:249] op_sel:[0,0,1] op_sel_hi:[1,0,1]
    v_pk_mul_f32 v[132:133], v[132:133], v[84:85]
    v_pk_mul_f32 v[134:135], v[134:135], v[86:87]
    v_pk_mul_f32 v[136:137], v[136:137], v[88:89]
    v_pk_mul_f32 v[138:139], v[138:139], v[90:91]
    v_pk_mul_f32 v[140:141], v[140:141], v[92:93]
    s_waitcnt vmcnt(35)
    ds_read_b64_tr_b16 a[48:49], v185 offset:12288
    ds_read_b64_tr_b16 a[50:51], v185 offset:12800
    ds_read_b64_tr_b16 a[52:53], v184 offset:12288
    ds_read_b64_tr_b16 a[54:55], v184 offset:12800
    ds_read_b64_tr_b16 a[56:57], v185 offset:14336
    ds_read_b64_tr_b16 a[58:59], v185 offset:14848
    ds_read_b64_tr_b16 a[60:61], v184 offset:14336
    ds_read_b64_tr_b16 a[62:63], v184 offset:14848
    v_pk_mul_f32 v[142:143], v[142:143], v[94:95]
    v_pk_mul_f32 v[144:145], v[144:145], v[96:97]
    v_pk_mul_f32 v[146:147], v[146:147], v[98:99]
    v_exp_f32 v132, v132
    v_exp_f32 v133, v133
    v_exp_f32 v134, v134
    v_exp_f32 v135, v135
    v_exp_f32 v136, v136
    v_exp_f32 v137, v137
    v_exp_f32 v138, v138
    s_waitcnt lgkmcnt(0)
    s_mul_i32 s51, s49, 28672
    s_add_u32 m0, s44, 12288
    s_add_u32 s51, s51, s45
    s_add_u32 s49, s49, 1
    s_cmp_eq_u32 s49, 14
    s_cselect_b32 s49, 0, s49
    buffer_load_dwordx4 v206, s[36:39], s51 offen offset:0 lds
    v_exp_f32 v139, v139
    v_exp_f32 v140, v140
    v_exp_f32 v141, v141
    v_exp_f32 v142, v142
    v_exp_f32 v143, v143
    v_exp_f32 v144, v144
    v_exp_f32 v145, v145
    v_exp_f32 v146, v146
    buffer_load_dwordx4 v205, s[36:39], s51 offen offset:1024 lds
    v_exp_f32 v147, v147
    v_pk_add_f32 v[132:133], v[132:133], 1.0 op_sel_hi:[1,0]
    v_pk_add_f32 v[134:135], v[134:135], 1.0 op_sel_hi:[1,0]
    v_pk_add_f32 v[136:137], v[136:137], 1.0 op_sel_hi:[1,0]
    v_pk_add_f32 v[138:139], v[138:139], 1.0 op_sel_hi:[1,0]
    v_pk_add_f32 v[140:141], v[140:141], 1.0 op_sel_hi:[1,0]
    v_pk_add_f32 v[142:143], v[142:143], 1.0 op_sel_hi:[1,0]
    v_pk_add_f32 v[144:145], v[144:145], 1.0 op_sel_hi:[1,0]
    v_pk_add_f32 v[146:147], v[146:147], 1.0 op_sel_hi:[1,0]
    v_rcp_f32 v132, v132
    v_rcp_f32 v133, v133
    v_rcp_f32 v134, v134
    buffer_load_dwordx4 v204, s[36:39], s51 offen offset:2048 lds
    v_rcp_f32 v135, v135
    v_rcp_f32 v136, v136
    v_rcp_f32 v137, v137
    v_rcp_f32 v138, v138
    v_rcp_f32 v139, v139
    v_rcp_f32 v140, v140
    v_rcp_f32 v141, v141
    v_rcp_f32 v142, v142
    buffer_load_dwordx4 v203, s[36:39], s51 offen offset:3072 lds
    v_rcp_f32 v143, v143
    v_rcp_f32 v144, v144
    v_rcp_f32 v145, v145
    v_rcp_f32 v146, v146
    v_rcp_f32 v147, v147
    v_pk_mul_f32 v[132:133], v[132:133], v[84:85]
    v_pk_mul_f32 v[134:135], v[134:135], v[86:87]
    v_pk_mul_f32 v[136:137], v[136:137], v[88:89]
    v_pk_mul_f32 v[138:139], v[138:139], v[90:91]
    v_pk_mul_f32 v[140:141], v[140:141], v[92:93]
    v_pk_mul_f32 v[142:143], v[142:143], v[94:95]
    v_pk_mul_f32 v[144:145], v[144:145], v[96:97]
    s_waitcnt vmcnt(34)
    ds_read_b64_tr_b16 a[64:65], v185 offset:16384
    ds_read_b64_tr_b16 a[66:67], v185 offset:16896
    ds_read_b64_tr_b16 a[68:69], v184 offset:16384
    ds_read_b64_tr_b16 a[70:71], v184 offset:16896
    ds_read_b64_tr_b16 a[72:73], v185 offset:18432
    ds_read_b64_tr_b16 a[74:75], v185 offset:18944
    ds_read_b64_tr_b16 a[76:77], v184 offset:18432
    ds_read_b64_tr_b16 a[78:79], v184 offset:18944
    v_pk_mul_f32 v[146:147], v[146:147], v[98:99]
    v_cvt_pk_bf16_f32 v216, v132, v133
    v_cvt_pk_bf16_f32 v217, v134, v135
    v_cvt_pk_bf16_f32 v218, v136, v137
    v_cvt_pk_bf16_f32 v219, v138, v139
    v_cvt_pk_bf16_f32 v220, v140, v141
    v_cvt_pk_bf16_f32 v221, v142, v143
    v_cvt_pk_bf16_f32 v222, v144, v145
    v_cvt_pk_bf16_f32 v223, v146, v147
    s_add_u32 s84, s79, 0
    buffer_store_dwordx4 v[148:151], v251, s[28:31], s84 offen sc1
    s_add_u32 s84, s79, 1024
    buffer_store_dwordx4 v[152:155], v251, s[28:31], s84 offen sc1
    s_add_u32 s84, s79, 2048
    buffer_store_dwordx4 v[164:167], v251, s[28:31], s84 offen sc1
    s_add_u32 s84, s79, 3072
    buffer_store_dwordx4 v[168:171], v251, s[28:31], s84 offen sc1
    s_add_u32 s84, s79, 4096
    buffer_store_dwordx4 v[208:211], v251, s[28:31], s84 offen sc1
    s_add_u32 s84, s79, 5120
    buffer_store_dwordx4 v[212:215], v251, s[28:31], s84 offen sc1
    s_add_u32 s84, s79, 6144
    buffer_store_dwordx4 v[216:219], v251, s[28:31], s84 offen sc1
    s_add_u32 s84, s79, 7168
    buffer_store_dwordx4 v[220:223], v251, s[28:31], s84 offen sc1
    s_nop 1
    s_lshl_b32 s84, s3, 2
    v_add_u32 v246, s84, v3
    v_cmp_gt_u32 s[98:99], s4, v246
    v_add_u32 v246, 2, v246
    v_cmp_gt_u32 s[100:101], s4, v246
    s_mov_b32 s82, 0
L_eg_chk:
    s_waitcnt vmcnt(16)
    v_cmp_ne_u32 vcc, s96, v38
    s_nop 1
    s_and_b64 s[80:81], vcc, s[98:99]
    s_waitcnt vmcnt(15)
    v_cmp_ne_u32 vcc, s96, v42
    s_nop 1
    s_and_b64 vcc, vcc, s[100:101]
    s_or_b64 vcc, vcc, s[80:81]
    s_nop 0
    s_cbranch_vccz L_eg_ok
    s_add_u32 s82, s82, 1
    s_cmp_gt_u32 s82, 0x8000
    s_cbranch_scc1 L_eg_ok
    s_sleep 1
    s_lshl_b32 s85, s5, 13
    s_lshl_b32 s84, s3, 11
    s_add_u32 s85, s85, s84
    s_add_u32 s85, s85, 11042816
    buffer_load_dwordx4 v[36:39], v250, s[28:31], s85 offen offset:0 sc1
    buffer_load_dwordx4 v[40:43], v250, s[28:31], s85 offen offset:1024 sc1
    s_waitcnt vmcnt(0)
    s_branch L_eg_chk
L_eg_ok:
    s_lshl_b32 s84, s3, 10
    s_add_u32 s84, s84, 157184
    v_lshl_add_u32 v246, v1, 3, s84
    ds_write_b64 v246, v[36:37] offset:0
    ds_write_b64 v246, v[40:41] offset:512
    s_mov_b32 s84, 157184
    v_lshl_add_u32 v246, v1, 3, s84
    s_waitcnt lgkmcnt(0)
    s_barrier
    ds_read_b64 v[244:245], v246 offset:0
    ds_read_b64 v[242:243], v246 offset:512
    ds_read_b64 v[240:241], v246 offset:1024
    ds_read_b64 v[238:239], v246 offset:1536
    ds_read_b64 v[236:237], v246 offset:2048
    ds_read_b64 v[234:235], v246 offset:2560
    ds_read_b64 v[228:229], v246 offset:3072
    ds_read_b64 v[226:227], v246 offset:3584
    v_mov_b32 v252, 0
    v_mov_b32 v253, 0
    s_mov_b64 exec, s[60:61]
    s_waitcnt lgkmcnt(7)
    v_fma_f32 v254, v190, v252, v244
    v_fma_f32 v255, v190, v253, v245
    v_fma_f32 v254, -v191, v253, v254
    v_fma_f32 v253, v191, v252, v255
    v_mov_b32 v252, v254
    s_mov_b64 exec, s[62:63]
    s_waitcnt lgkmcnt(6)
    v_fma_f32 v254, v190, v252, v242
    v_fma_f32 v255, v190, v253, v243
    v_fma_f32 v254, -v191, v253, v254
    v_fma_f32 v253, v191, v252, v255
    v_mov_b32 v252, v254
    s_mov_b64 exec, s[64:65]
    s_waitcnt lgkmcnt(5)
    v_fma_f32 v254, v190, v252, v240
    v_fma_f32 v255, v190, v253, v241
    v_fma_f32 v254, -v191, v253, v254
    v_fma_f32 v253, v191, v252, v255
    v_mov_b32 v252, v254
    s_mov_b64 exec, s[66:67]
    s_waitcnt lgkmcnt(4)
    v_fma_f32 v254, v190, v252, v238
    v_fma_f32 v255, v190, v253, v239
    v_fma_f32 v254, -v191, v253, v254
    v_fma_f32 v253, v191, v252, v255
    v_mov_b32 v252, v254
    s_mov_b64 exec, s[68:69]
    s_waitcnt lgkmcnt(3)
    v_fma_f32 v254, v190, v252, v236
    v_fma_f32 v255, v190, v253, v237
    v_fma_f32 v254, -v191, v253, v254
    v_fma_f32 v253, v191, v252, v255
    v_mov_b32 v252, v254
    s_mov_b64 exec, s[70:71]
    s_waitcnt lgkmcnt(2)
    v_fma_f32 v254, v190, v252, v234
    v_fma_f32 v255, v190, v253, v235
    v_fma_f32 v254, -v191, v253, v254
    v_fma_f32 v253, v191, v252, v255
    v_mov_b32 v252, v254
    s_mov_b64 exec, s[72:73]
    s_waitcnt lgkmcnt(1)
    v_fma_f32 v254, v190, v252, v228
    v_fma_f32 v255, v190, v253, v229
    v_fma_f32 v254, -v191, v253, v254
    v_fma_f32 v253, v191, v252, v255
    v_mov_b32 v252, v254
    s_mov_b64 exec, s[74:75]
    s_waitcnt lgkmcnt(0)
    v_fma_f32 v254, v190, v252, v226
    v_fma_f32 v255, v190, v253, v227
    v_fma_f32 v254, -v191, v253, v254
    v_fma_f32 v253, v191, v252, v255
    v_mov_b32 v252, v254
    s_and_b32 s84, s4, 1
    s_cmp_eq_u32 s84, 1
    s_cselect_b32 exec_lo, 0, -1
    s_cselect_b32 exec_hi, -1, 0
    v_mul_f32 v254, v192, v252
    v_mul_f32 v255, v192, v253
    v_fma_f32 v254, -v193, v253, v254
    v_fma_f32 v253, v193, v252, v255
    v_mov_b32 v252, v254
    s_mov_b64 exec, -1
    v_mov_b32 v254, v252
    v_mov_b32 v255, v253
    s_nop 0
    v_permlane32_swap_b32 v252, v254
    v_permlane32_swap_b32 v253, v255
    v_add_f32 v252, v252, v254
    v_add_f32 v253, v253, v255
    v_fma_f32 v254, v194, v252, v174
    v_fma_f32 v255, v194, v253, v175
    v_fma_f32 v254, -v195, v253, v254
    v_fma_f32 v249, v195, v252, v255
    v_mov_b32 v248, v254
    v_fmac_f32 v4, v198, v248
    v_fmac_f32 v20, v198, v249
    v_fma_f32 v4, -v199, v249, v4
    v_fmac_f32 v20, v199, v248
    v_fmac_f32 v5, v198, v4
    v_fmac_f32 v21, v198, v20
    v_fma_f32 v5, -v199, v20, v5
    s_mul_i32 s51, s49, 28672
    s_add_u32 m0, s44, 16384
    s_add_u32 s51, s51, s45
    s_add_u32 s49, s49, 1
    s_cmp_eq_u32 s49, 14
    s_cselect_b32 s49, 0, s49
    buffer_load_dwordx4 v206, s[36:39], s51 offen offset:0 lds
    v_fmac_f32 v21, v199, v4
    v_fmac_f32 v6, v198, v5
    v_fmac_f32 v22, v198, v21
    v_fma_f32 v6, -v199, v21, v6
    v_fmac_f32 v22, v199, v5
    v_fmac_f32 v7, v198, v6
    v_fmac_f32 v23, v198, v22
    v_fma_f32 v7, -v199, v22, v7
    v_fmac_f32 v23, v199, v6
    v_fmac_f32 v8, v198, v7
    v_fmac_f32 v24, v198, v23
    v_fma_f32 v8, -v199, v23, v8
    v_fmac_f32 v24, v199, v7
    v_fmac_f32 v9, v198, v8
    v_fmac_f32 v25, v198, v24
    v_fma_f32 v9, -v199, v24, v9
    buffer_load_dwordx4 v205, s[36:39], s51 offen offset:1024 lds
    v_fmac_f32 v25, v199, v8
    v_fmac_f32 v10, v198, v9
    v_fmac_f32 v26, v198, v25
    v_fma_f32 v10, -v199, v25, v10
    v_fmac_f32 v26, v199, v9
    v_fmac_f32 v11, v198, v10
    v_fmac_f32 v27, v198, v26
    v_fma_f32 v11, -v199, v26, v11
    v_fmac_f32 v27, v199, v10
    v_fmac_f32 v12, v198, v11
    v_fmac_f32 v28, v198, v27
    v_fma_f32 v12, -v199, v27, v12
    v_fmac_f32 v28, v199, v11
    v_fmac_f32 v13, v198, v12
    v_fmac_f32 v29, v198, v28
    v_fma_f32 v13, -v199, v28, v13
    buffer_load_dwordx4 v204, s[36:39], s51 offen offset:2048 lds
    v_fmac_f32 v29, v199, v12
    v_fmac_f32 v14, v198, v13
    v_fmac_f32 v30, v198, v29
    v_fma_f32 v14, -v199, v29, v14
    v_fmac_f32 v30, v199, v13
    v_fmac_f32 v15, v198, v14
    v_fmac_f32 v31, v198, v30
    v_fma_f32 v15, -v199, v30, v15
    v_fmac_f32 v31, v199, v14
    v_fmac_f32 v16, v198, v15
    v_fmac_f32 v32, v198, v31
    v_fma_f32 v16, -v199, v31, v16
    v_fmac_f32 v32, v199, v15
    v_fmac_f32 v17, v198, v16
    v_fmac_f32 v33, v198, v32
    v_fma_f32 v17, -v199, v32, v17
    v_fmac_f32 v33, v199, v16
    buffer_load_dwordx4 v203, s[36:39], s51 offen offset:3072 lds
    v_fmac_f32 v18, v198, v17
    v_fmac_f32 v34, v198, v33
    v_fma_f32 v18, -v199, v33, v18
    v_fmac_f32 v34, v199, v17
    v_fmac_f32 v19, v198, v18
    v_fmac_f32 v35, v198, v34
    v_fma_f32 v19, -v199, v34, v19
    v_fmac_f32 v35, v199, v18
    v_cvt_pk_bf16_f32 v36, v4, v5
    v_cvt_pk_bf16_f32 v37, v6, v7
    v_cvt_pk_bf16_f32 v38, v8, v9
    v_cvt_pk_bf16_f32 v39, v10, v11
    v_cvt_pk_bf16_f32 v40, v12, v13
    v_cvt_pk_bf16_f32 v41, v14, v15
    v_cvt_pk_bf16_f32 v42, v16, v17
    v_cvt_pk_bf16_f32 v43, v18, v19
    v_cvt_pk_bf16_f32 v44, v20, v21
    v_cvt_pk_bf16_f32 v45, v22, v23
    v_cvt_pk_bf16_f32 v46, v24, v25
    v_cvt_pk_bf16_f32 v47, v26, v27
    v_cvt_pk_bf16_f32 v48, v28, v29
    v_cvt_pk_bf16_f32 v49, v30, v31
    v_cvt_pk_bf16_f32 v50, v32, v33
    v_cvt_pk_bf16_f32 v51, v34, v35
    v_mfma_f32_32x32x16_bf16 v[52:67], v[36:39], v[156:159], 0
    v_mfma_f32_32x32x16_bf16 v[68:83], v[44:47], v[156:159], 0
    v_mfma_f32_32x32x16_bf16 v[52:67], v[40:43], v[160:163], v[52:67]
    v_mfma_f32_32x32x16_bf16 v[68:83], v[48:51], v[160:163], v[68:83]
    s_lshl_b32 s78, s4, 2
    s_add_u32 s78, s78, s3
    s_mul_i32 s78, s78, 56
    s_lshl_b32 s84, s5, 1
    s_add_u32 s78, s78, s84
    s_lshl_b32 s78, s78, 10
    s_add_u32 s78, s78, 7340032
    s_nop 3
    v_cvt_pk_bf16_f32 v36, v52, v53
    v_cvt_pk_bf16_f32 v37, v54, v55
    v_cvt_pk_bf16_f32 v38, v56, v57
    v_cvt_pk_bf16_f32 v39, v58, v59
    v_cvt_pk_bf16_f32 v40, v60, v61
    v_cvt_pk_bf16_f32 v41, v62, v63
    v_cvt_pk_bf16_f32 v42, v64, v65
    v_cvt_pk_bf16_f32 v43, v66, v67
    s_add_u32 s84, s78, 0
    buffer_store_dwordx4 v[36:39], v251, s[28:31], s84 offen sc1
    s_add_u32 s84, s78, 1024
    buffer_store_dwordx4 v[40:43], v251, s[28:31], s84 offen sc1
    v_cvt_pk_bf16_f32 v44, v68, v69
    v_cvt_pk_bf16_f32 v45, v70, v71
    v_cvt_pk_bf16_f32 v46, v72, v73
    v_cvt_pk_bf16_f32 v47, v74, v75
    v_cvt_pk_bf16_f32 v48, v76, v77
    v_cvt_pk_bf16_f32 v49, v78, v79
    v_cvt_pk_bf16_f32 v50, v80, v81
    v_cvt_pk_bf16_f32 v51, v82, v83
    s_add_u32 s84, s78, 28672
    buffer_store_dwordx4 v[44:47], v251, s[28:31], s84 offen sc1
    s_add_u32 s84, s78, 29696
    buffer_store_dwordx4 v[48:51], v251, s[28:31], s84 offen sc1
    s_nop 1
    ds_read_b64_tr_b16 a[80:81], v185 offset:20480
    ds_read_b64_tr_b16 a[82:83], v185 offset:20992
    ds_read_b64_tr_b16 a[84:85], v184 offset:20480
    ds_read_b64_tr_b16 a[86:87], v184 offset:20992
    ds_read_b64_tr_b16 a[88:89], v185 offset:22528
    ds_read_b64_tr_b16 a[90:91], v185 offset:23040
    ds_read_b64_tr_b16 a[92:93], v184 offset:22528
    ds_read_b64_tr_b16 a[94:95], v184 offset:23040
    ds_read_b64_tr_b16 a[96:97], v185 offset:24576
    ds_read_b64_tr_b16 a[98:99], v185 offset:25088
    ds_read_b64_tr_b16 a[100:101], v184 offset:24576
    ds_read_b64_tr_b16 a[102:103], v184 offset:25088
    ds_read_b64_tr_b16 a[104:105], v185 offset:26624
    ds_read_b64_tr_b16 a[106:107], v185 offset:27136
    ds_read_b64_tr_b16 a[108:109], v184 offset:26624
    ds_read_b64_tr_b16 a[110:111], v184 offset:27136
    s_waitcnt lgkmcnt(0)
    s_and_b32 s51, s3, 1
    s_lshl_b32 s51, s51, 2
    s_add_u32 s51, s51, s50
    s_add_u32 s50, s50, 1
    s_cmp_eq_u32 s50, 3
    s_cselect_b32 s50, 0, s50
    s_lshl_b32 s51, s51, 7
    s_add_u32 m0, s44, 20480
    s_add_u32 s51, s51, s46
    buffer_load_dwordx4 v202, s[32:35], s51 offen offset:0 lds
    buffer_load_dwordx4 v201, s[32:35], s51 offen offset:1024 lds
    buffer_load_dwordx4 v187, s[32:35], s51 offen offset:2048 lds
    buffer_load_dwordx4 v186, s[32:35], s51 offen offset:3072 lds
    s_add_u32 m0, s44, 24576
    s_add_u32 s51, s51, 28672
    buffer_load_dwordx4 v202, s[32:35], s51 offen offset:0 lds
    buffer_load_dwordx4 v201, s[32:35], s51 offen offset:1024 lds
    buffer_load_dwordx4 v187, s[32:35], s51 offen offset:2048 lds
    buffer_load_dwordx4 v186, s[32:35], s51 offen offset:3072 lds
    s_lshr_b32 s84, s3, 1
    s_lshl_b32 s85, s4, 1
    s_add_u32 s84, s84, s85
    s_mul_i32 s84, s84, 28
    s_and_b32 s85, s3, 1
    s_lshl_b32 s78, s5, 1
    s_add_u32 s85, s85, s78
    s_add_u32 s84, s84, s85
    s_lshl_b32 s84, s84, 7
    s_add_u32 s84, s84, 11157504
    v_mov_b32 v255, s96
    v_cmp_eq_u32 vcc, 0, v1
    v_mov_b32 v254, 33554432
    s_nop 0
    v_cndmask_b32 v254, v254, 0, vcc
    s_waitcnt vmcnt(16)
    buffer_store_dword v255, v254, s[28:31], s84 offen sc1
    s_mov_b32 s40, s76
    s_and_b32 s41, s77, 0xffff
    s_mov_b32 s42, 3670016
    s_mov_b32 s43, 0x20000
    v_bfe_u32 v255, v2, 2, 1
    v_lshlrev_b32 v255, 4, v255
    v_lshrrev_b32 v254, 3, v2
    v_lshl_add_u32 v255, v254, 2, v255
    v_and_b32 v254, 3, v2
    v_add_u32 v251, v255, v254
    s_lshl_b32 s58, s6, 6
    s_lshr_b32 s84, s3, 1
    s_lshl_b32 s84, s84, 5
    s_add_u32 s58, s58, s84
    s_lshl_b32 s59, s7, 6
    s_and_b32 s84, s3, 1
    s_lshl_b32 s84, s84, 5
    s_add_u32 s59, s59, s84
    v_lshrrev_b32 v255, 2, v1
    s_movk_i32 s85, 896
    v_mul_u32_u24 v255, s85, v255
    v_and_b32 v254, 3, v1
    v_lshl_add_u32 v255, v254, 4, v255
    v_add_u32 v254, 13312, v255
    s_mul_i32 s84, s58, 896
    s_lshl_b32 s85, s59, 1
    s_add_u32 s84, s84, s85
    s_lshl_b32 s85, s3, 11
    s_add_u32 s83, s85, 147456
    s_mov_b32 s82, m0
    s_mov_b32 m0, s83
    v_lshlrev_b32 v253, 4, v251
    buffer_load_dwordx4 v255, s[12:15], s84 offen lds
    buffer_load_dwordx4 v254, s[12:15], s84 offen offset:1024 lds
    s_mov_b32 m0, s82
    s_lshl_b32 s84, s58, 4
    s_add_u32 s84, s84, 11010048
    buffer_load_dwordx4 v[76:79], v253, s[28:31], s84 offen sc1
    ds_read_b64_tr_b16 a[112:113], v185 offset:28672
    ds_read_b64_tr_b16 a[114:115], v185 offset:29184
    ds_read_b64_tr_b16 a[116:117], v184 offset:28672
    ds_read_b64_tr_b16 a[118:119], v184 offset:29184
    ds_read_b64_tr_b16 a[120:121], v185 offset:30720
    ds_read_b64_tr_b16 a[122:123], v185 offset:31232
    ds_read_b64_tr_b16 a[124:125], v184 offset:30720
    ds_read_b64_tr_b16 a[126:127], v184 offset:31232
    ds_read_b64_tr_b16 a[128:129], v185 offset:32768
    ds_read_b64_tr_b16 a[130:131], v185 offset:33280
    ds_read_b64_tr_b16 a[132:133], v184 offset:32768
    ds_read_b64_tr_b16 a[134:135], v184 offset:33280
    ds_read_b64_tr_b16 a[136:137], v185 offset:34816
    ds_read_b64_tr_b16 a[138:139], v185 offset:35328
    ds_read_b64_tr_b16 a[140:141], v184 offset:34816
    ds_read_b64_tr_b16 a[142:143], v184 offset:35328
    s_waitcnt lgkmcnt(0)
    s_and_b32 s51, s3, 1
    s_lshl_b32 s51, s51, 2
    s_add_u32 s51, s51, s50
    s_add_u32 s50, s50, 1
    s_cmp_eq_u32 s50, 3
    s_cselect_b32 s50, 0, s50
    s_lshl_b32 s51, s51, 7
    s_add_u32 m0, s44, 28672
    s_add_u32 s51, s51, s46
    buffer_load_dwordx4 v202, s[32:35], s51 offen offset:0 lds
    buffer_load_dwordx4 v201, s[32:35], s51 offen offset:1024 lds
    buffer_load_dwordx4 v187, s[32:35], s51 offen offset:2048 lds
    buffer_load_dwordx4 v186, s[32:35], s51 offen offset:3072 lds
    s_add_u32 m0, s44, 32768
    s_add_u32 s51, s51, 28672
    buffer_load_dwordx4 v202, s[32:35], s51 offen offset:0 lds
    buffer_load_dwordx4 v201, s[32:35], s51 offen offset:1024 lds
    buffer_load_dwordx4 v187, s[32:35], s51 offen offset:2048 lds
    buffer_load_dwordx4 v186, s[32:35], s51 offen offset:3072 lds
    ds_read_b64_tr_b16 a[144:145], v185 offset:0
    ds_read_b64_tr_b16 a[146:147], v185 offset:512
    ds_read_b64_tr_b16 a[148:149], v184 offset:0
    ds_read_b64_tr_b16 a[150:151], v184 offset:512
    ds_read_b64_tr_b16 a[152:153], v185 offset:2048
    ds_read_b64_tr_b16 a[154:155], v185 offset:2560
    ds_read_b64_tr_b16 a[156:157], v184 offset:2048
    ds_read_b64_tr_b16 a[158:159], v184 offset:2560
    ds_read_b64_tr_b16 a[160:161], v185 offset:4096
    ds_read_b64_tr_b16 a[162:163], v185 offset:4608
    ds_read_b64_tr_b16 a[164:165], v184 offset:4096
    ds_read_b64_tr_b16 a[166:167], v184 offset:4608
    ds_read_b64_tr_b16 a[168:169], v185 offset:6144
    ds_read_b64_tr_b16 a[170:171], v185 offset:6656
    ds_read_b64_tr_b16 a[172:173], v184 offset:6144
    ds_read_b64_tr_b16 a[174:175], v184 offset:6656
    s_waitcnt lgkmcnt(0)
    s_and_b32 s51, s3, 1
    s_lshl_b32 s51, s51, 2
    s_add_u32 s51, s51, s50
    s_add_u32 s50, s50, 1
    s_cmp_eq_u32 s50, 3
    s_cselect_b32 s50, 0, s50
    s_lshl_b32 s51, s51, 7
    s_add_u32 m0, s44, 0
    s_add_u32 s51, s51, s46
    buffer_load_dwordx4 v202, s[32:35], s51 offen offset:0 lds
    buffer_load_dwordx4 v201, s[32:35], s51 offen offset:1024 lds
    buffer_load_dwordx4 v187, s[32:35], s51 offen offset:2048 lds
    buffer_load_dwordx4 v186, s[32:35], s51 offen offset:3072 lds
    s_add_u32 m0, s44, 4096
    s_add_u32 s51, s51, 28672
    buffer_load_dwordx4 v202, s[32:35], s51 offen offset:0 lds
    buffer_load_dwordx4 v201, s[32:35], s51 offen offset:1024 lds
    buffer_load_dwordx4 v187, s[32:35], s51 offen offset:2048 lds
    buffer_load_dwordx4 v186, s[32:35], s51 offen offset:3072 lds
    ds_read_b64_tr_b16 a[176:177], v185 offset:8192
    ds_read_b64_tr_b16 a[178:179], v185 offset:8704
    ds_read_b64_tr_b16 a[180:181], v184 offset:8192
    ds_read_b64_tr_b16 a[182:183], v184 offset:8704
    ds_read_b64_tr_b16 a[184:185], v185 offset:10240
    ds_read_b64_tr_b16 a[186:187], v185 offset:10752
    ds_read_b64_tr_b16 a[188:189], v184 offset:10240
    ds_read_b64_tr_b16 a[190:191], v184 offset:10752
    ds_read_b64_tr_b16 a[192:193], v185 offset:12288
    ds_read_b64_tr_b16 a[194:195], v185 offset:12800
    ds_read_b64_tr_b16 a[196:197], v184 offset:12288
    ds_read_b64_tr_b16 a[198:199], v184 offset:12800
    ds_read_b64_tr_b16 a[200:201], v185 offset:14336
    ds_read_b64_tr_b16 a[202:203], v185 offset:14848
    ds_read_b64_tr_b16 a[204:205], v184 offset:14336
    ds_read_b64_tr_b16 a[206:207], v184 offset:14848
    s_waitcnt lgkmcnt(0)
    s_mov_b32 s51, 3
    s_lshl_b32 s51, s51, 7
    s_add_u32 m0, s44, 8192
    s_add_u32 s51, s51, s46
    buffer_load_dwordx4 v202, s[32:35], s51 offen offset:0 lds
    buffer_load_dwordx4 v201, s[32:35], s51 offen offset:1024 lds
    buffer_load_dwordx4 v187, s[32:35], s51 offen offset:2048 lds
    buffer_load_dwordx4 v186, s[32:35], s51 offen offset:3072 lds
    s_add_u32 m0, s44, 12288
    s_add_u32 s51, s51, 28672
    buffer_load_dwordx4 v202, s[32:35], s51 offen offset:0 lds
    buffer_load_dwordx4 v201, s[32:35], s51 offen offset:1024 lds
    buffer_load_dwordx4 v187, s[32:35], s51 offen offset:2048 lds
    buffer_load_dwordx4 v186, s[32:35], s51 offen offset:3072 lds
    s_waitcnt vmcnt(40)
    ds_read_b64_tr_b16 a[208:209], v185 offset:16384
    ds_read_b64_tr_b16 a[210:211], v185 offset:16896
    ds_read_b64_tr_b16 a[212:213], v184 offset:16384
    ds_read_b64_tr_b16 a[214:215], v184 offset:16896
    ds_read_b64_tr_b16 a[216:217], v185 offset:18432
    ds_read_b64_tr_b16 a[218:219], v185 offset:18944
    ds_read_b64_tr_b16 a[220:221], v184 offset:18432
    ds_read_b64_tr_b16 a[222:223], v184 offset:18944
    s_waitcnt vmcnt(28)
    ds_read_b128 a[224:227], v183 offset:20480
    ds_read_b128 a[228:231], v182 offset:20480
    ds_read_b128 a[232:235], v181 offset:20480
    ds_read_b128 a[236:239], v180 offset:20480
    ds_read_b128 a[240:243], v179 offset:20480
    ds_read_b128 a[244:247], v178 offset:20480
    ds_read_b128 a[248:251], v177 offset:20480
    ds_read_b128 a[252:255], v176 offset:20480
    v_min_u32 v250, 27, v1
    v_lshlrev_b32 v250, 7, v250
    s_mov_b32 s52, 0x0fffffff
    s_mov_b32 s53, 0
    s_mul_i32 s57, s6, 3584
    s_add_u32 s57, s57, 11157504
    buffer_load_dword v249, v250, s[28:31], s57 offen sc1
    v_lshlrev_b32 v255, 4, v3
    s_and_b32 s84, s3, 1
    s_lshl_b32 s84, s84, 7
    s_add_u32 s84, s84, 155648
    v_add_u32 v255, s84, v255
    v_lshlrev_b32 v254, 6, v251
    v_lshl_add_u32 v254, v3, 3, v254
    v_add_u32 v254, s83, v254
    ds_read_b128 v[60:63], v255 offset:0
    ds_read_b128 v[36:39], v255 offset:256
    ds_read_b128 v[64:67], v255 offset:32
    ds_read_b128 v[40:43], v255 offset:288
    ds_read_b128 v[68:71], v255 offset:64
    ds_read_b128 v[44:47], v255 offset:320
    ds_read_b128 v[72:75], v255 offset:96
    ds_read_b128 v[48:51], v255 offset:352
    s_waitcnt vmcnt(26)
    ds_read_b64 v[52:53], v254 offset:0
    ds_read_b64 v[54:55], v254 offset:16
    ds_read_b64 v[56:57], v254 offset:32
    ds_read_b64 v[58:59], v254 offset:48
    s_waitcnt vmcnt(25) lgkmcnt(11)
    v_mul_f32 v60, v60, v77
    v_mul_f32 v61, v61, v77
    v_mul_f32 v62, v62, v77
    v_mul_f32 v63, v63, v77
    s_waitcnt lgkmcnt(9)
    v_mul_f32 v64, v64, v77
    v_mul_f32 v65, v65, v77
    v_mul_f32 v66, v66, v77
    v_mul_f32 v67, v67, v77
    s_waitcnt lgkmcnt(7)
    v_mul_f32 v68, v68, v77
    v_mul_f32 v69, v69, v77
    v_mul_f32 v70, v70, v77
    v_mul_f32 v71, v71, v77
    s_waitcnt lgkmcnt(5)
    v_mul_f32 v72, v72, v77
    v_mul_f32 v73, v73, v77
    v_mul_f32 v74, v74, v77
    v_mul_f32 v75, v75, v77
    s_waitcnt lgkmcnt(3)
    v_lshlrev_b32 v4, 16, v52
    v_and_b32 v5, 0xffff0000, v52
    v_lshlrev_b32 v6, 16, v53
    v_and_b32 v7, 0xffff0000, v53
    s_waitcnt lgkmcnt(2)
    v_lshlrev_b32 v8, 16, v54
    v_and_b32 v9, 0xffff0000, v54
    v_lshlrev_b32 v10, 16, v55
    v_and_b32 v11, 0xffff0000, v55
    s_waitcnt lgkmcnt(1)
    v_lshlrev_b32 v12, 16, v56
    v_and_b32 v13, 0xffff0000, v56
    v_lshlrev_b32 v14, 16, v57
    v_and_b32 v15, 0xffff0000, v57
    s_waitcnt lgkmcnt(0)
    v_lshlrev_b32 v16, 16, v58
    v_and_b32 v17, 0xffff0000, v58
    v_lshlrev_b32 v18, 16, v59
    v_and_b32 v19, 0xffff0000, v59
    v_sub_f32 v20, v4, v76
    v_sub_f32 v21, v5, v76
    v_sub_f32 v22, v6, v76
    v_sub_f32 v23, v7, v76
    v_sub_f32 v24, v8, v76
    v_sub_f32 v25, v9, v76
    v_sub_f32 v26, v10, v76
    v_sub_f32 v27, v11, v76
    v_sub_f32 v28, v12, v76
    v_sub_f32 v29, v13, v76
    v_sub_f32 v30, v14, v76
    v_sub_f32 v31, v15, v76
    v_sub_f32 v32, v16, v76
    v_sub_f32 v33, v17, v76
    v_sub_f32 v34, v18, v76
    v_sub_f32 v35, v19, v76
    v_mul_f32 v20, v20, v60
    v_mul_f32 v21, v21, v61
    v_mul_f32 v22, v22, v62
    v_mul_f32 v23, v23, v63
    v_mul_f32 v24, v24, v64
    v_mul_f32 v25, v25, v65
    v_mul_f32 v26, v26, v66
    v_mul_f32 v27, v27, v67
    v_mul_f32 v28, v28, v68
    v_mul_f32 v29, v29, v69
    v_mul_f32 v30, v30, v70
    v_mul_f32 v31, v31, v71
    v_mul_f32 v32, v32, v72
    v_mul_f32 v33, v33, v73
    v_mul_f32 v34, v34, v74
    v_mul_f32 v35, v35, v75
    v_lshlrev_b32 v248, 4, v1
    s_lshr_b32 s84, s3, 1
    s_mul_i32 s85, s84, 114688
    v_add_u32 v255, s85, v248
    s_sub_u32 s85, 114688, s85
    v_add_u32 v254, s85, v248
    s_mul_i32 s85, s84, 57344
    v_add_u32 v253, s85, v248
    s_sub_u32 s85, 57344, s85
    v_add_u32 v252, s85, v248
    s_lshl_b32 s54, s6, 1
    s_mul_i32 s84, s54, 112
    s_mul_i32 s85, s3, 28
    s_add_u32 s84, s84, s85
    s_lshl_b32 s84, s84, 10
    s_mul_i32 s55, s54, 56
    s_lshr_b32 s85, s3, 1
    s_mul_i32 s85, s85, 28
    s_add_u32 s55, s55, s85
    s_lshl_b32 s55, s55, 10
    s_add_u32 s55, s55, 7340032
    s_mov_b32 s54, s84
    s_mov_b32 s49, s47
    s_mov_b32 s50, s48
    s_mov_b32 s85, 0
L_pm_chk:
    s_waitcnt vmcnt(0)
    v_cmp_ne_u32 vcc, s96, v249
    s_nop 1
    s_and_b64 vcc, vcc, s[52:53]
    s_nop 1
    s_cbranch_vccz L_pm_ok
    s_add_u32 s85, s85, 1
    s_cmp_gt_u32 s85, 0x8000
    s_cbranch_scc1 L_pm_ok
    s_sleep 1
    buffer_load_dword v249, v250, s[28:31], s57 offen sc1
    s_waitcnt vmcnt(0)
    s_branch L_pm_chk
L_pm_ok:
    s_lshl_b32 s56, s49, 11
    s_add_u32 s56, s56, s54
    s_add_u32 s49, s49, 1
    s_cmp_eq_u32 s49, 14
    s_cselect_b32 s49, 0, s49
    buffer_load_dwordx4 v[148:151], v255, s[28:31], s56 offen offset:0 sc1
    buffer_load_dwordx4 v[152:155], v254, s[28:31], s56 offen offset:0 sc1
    buffer_load_dwordx4 v[156:159], v255, s[28:31], s56 offen offset:1024 sc1
    buffer_load_dwordx4 v[160:163], v254, s[28:31], s56 offen offset:1024 sc1
    s_lshl_b32 s56, s49, 11
    s_add_u32 s56, s56, s54
    s_add_u32 s49, s49, 1
    s_cmp_eq_u32 s49, 14
    s_cselect_b32 s49, 0, s49
    buffer_load_dwordx4 v[164:167], v255, s[28:31], s56 offen offset:0 sc1
    buffer_load_dwordx4 v[168:171], v254, s[28:31], s56 offen offset:0 sc1
    buffer_load_dwordx4 v[172:175], v255, s[28:31], s56 offen offset:1024 sc1
    buffer_load_dwordx4 v[184:187], v254, s[28:31], s56 offen offset:1024 sc1
    s_lshl_b32 s56, s49, 11
    s_add_u32 s56, s56, s54
    s_add_u32 s49, s49, 1
    s_cmp_eq_u32 s49, 14
    s_cselect_b32 s49, 0, s49
    buffer_load_dwordx4 v[188:191], v255, s[28:31], s56 offen offset:0 sc1
    buffer_load_dwordx4 v[192:195], v254, s[28:31], s56 offen offset:0 sc1
    buffer_load_dwordx4 v[196:199], v255, s[28:31], s56 offen offset:1024 sc1
    buffer_load_dwordx4 v[200:203], v254, s[28:31], s56 offen offset:1024 sc1
    v_lshlrev_b32 v248, 4, v1
    s_waitcnt vmcnt(11)
    v_mfma_f32_32x32x16_bf16 v[36:51], a[0:3], v[148:151], v[36:51]
    v_mfma_f32_32x32x16_bf16 v[52:67], a[4:7], v[148:151], 0
    s_waitcnt vmcnt(10)
    v_mfma_f32_32x32x16_bf16 v[68:83], a[0:3], v[152:155], 0
    v_mfma_f32_32x32x16_bf16 v[84:99], a[4:7], v[152:155], 0
    s_lshr_b32 s84, s3, 1
    s_lshl_b32 s85, s4, 1
    s_add_u32 s84, s84, s85
    s_mul_i32 s84, s84, 28
    s_and_b32 s85, s3, 1
    s_lshl_b32 s78, s5, 1
    s_add_u32 s85, s85, s78
    s_add_u32 s84, s84, s85
    s_lshl_b32 s84, s84, 7
    s_add_u32 s84, s84, 11272192
    v_mov_b32 v247, s96
    v_cmp_eq_u32 vcc, 0, v1
    v_mov_b32 v246, 33554432
    s_nop 0
    v_cndmask_b32 v246, v246, 0, vcc
    buffer_store_dword v247, v246, s[28:31], s84 offen sc1
    s_lshl_b32 s56, s49, 11
    s_add_u32 s56, s56, s54
    s_add_u32 s49, s49, 1
    s_cmp_eq_u32 s49, 14
    s_cselect_b32 s49, 0, s49
    buffer_load_dwordx4 v[148:151], v255, s[28:31], s56 offen offset:0 sc1
    buffer_load_dwordx4 v[152:155], v254, s[28:31], s56 offen offset:0 sc1
    s_waitcnt vmcnt(12)
    v_mfma_f32_32x32x16_bf16 v[36:51], a[8:11], v[156:159], v[36:51]
    v_mfma_f32_32x32x16_bf16 v[52:67], a[12:15], v[156:159], v[52:67]
    s_waitcnt vmcnt(11)
    v_mfma_f32_32x32x16_bf16 v[68:83], a[8:11], v[160:163], v[68:83]
    v_mfma_f32_32x32x16_bf16 v[84:99], a[12:15], v[160:163], v[84:99]
    buffer_load_dwordx4 v[156:159], v255, s[28:31], s56 offen offset:1024 sc1
    buffer_load_dwordx4 v[160:163], v254, s[28:31], s56 offen offset:1024 sc1
    s_waitcnt vmcnt(12)
    v_mfma_f32_32x32x16_bf16 v[36:51], a[16:19], v[164:167], v[36:51]
    v_mfma_f32_32x32x16_bf16 v[52:67], a[20:23], v[164:167], v[52:67]
    s_waitcnt vmcnt(11)
    v_mfma_f32_32x32x16_bf16 v[68:83], a[16:19], v[168:171], v[68:83]
    v_mfma_f32_32x32x16_bf16 v[84:99], a[20:23], v[168:171], v[84:99]
    s_lshl_b32 s56, s49, 11
    s_add_u32 s56, s56, s54
    s_add_u32 s49, s49, 1
    s_cmp_eq_u32 s49, 14
    s_cselect_b32 s49, 0, s49
    buffer_load_dwordx4 v[164:167], v255, s[28:31], s56 offen offset:0 sc1
    buffer_load_dwordx4 v[168:171], v254, s[28:31], s56 offen offset:0 sc1
    s_waitcnt vmcnt(12)
    v_mfma_f32_32x32x16_bf16 v[36:51], a[24:27], v[172:175], v[36:51]
    v_mfma_f32_32x32x16_bf16 v[52:67], a[28:31], v[172:175], v[52:67]
    s_waitcnt vmcnt(11)
    v_mfma_f32_32x32x16_bf16 v[68:83], a[24:27], v[184:187], v[68:83]
    v_mfma_f32_32x32x16_bf16 v[84:99], a[28:31], v[184:187], v[84:99]
    buffer_load_dwordx4 v[172:175], v255, s[28:31], s56 offen offset:1024 sc1
    buffer_load_dwordx4 v[184:187], v254, s[28:31], s56 offen offset:1024 sc1
    s_waitcnt vmcnt(12)
    v_mfma_f32_32x32x16_bf16 v[36:51], a[32:35], v[188:191], v[36:51]
    v_mfma_f32_32x32x16_bf16 v[52:67], a[36:39], v[188:191], v[52:67]
    s_waitcnt vmcnt(11)
    v_mfma_f32_32x32x16_bf16 v[68:83], a[32:35], v[192:195], v[68:83]
    v_mfma_f32_32x32x16_bf16 v[84:99], a[36:39], v[192:195], v[84:99]
    s_lshl_b32 s56, s49, 11
    s_add_u32 s56, s56, s54
    s_add_u32 s49, s49, 1
    s_cmp_eq_u32 s49, 14
    s_cselect_b32 s49, 0, s49
    buffer_load_dwordx4 v[188:191], v255, s[28:31], s56 offen offset:0 sc1
    buffer_load_dwordx4 v[192:195], v254, s[28:31], s56 offen offset:0 sc1
    s_waitcnt vmcnt(12)
    v_mfma_f32_32x32x16_bf16 v[36:51], a[40:43], v[196:199], v[36:51]
    v_mfma_f32_32x32x16_bf16 v[52:67], a[44:47], v[196:199], v[52:67]
    s_waitcnt vmcnt(11)
    v_mfma_f32_32x32x16_bf16 v[68:83], a[40:43], v[200:203], v[68:83]
    v_mfma_f32_32x32x16_bf16 v[84:99], a[44:47], v[200:203], v[84:99]
    buffer_load_dwordx4 v[196:199], v255, s[28:31], s56 offen offset:1024 sc1
    buffer_load_dwordx4 v[200:203], v254, s[28:31], s56 offen offset:1024 sc1
    s_waitcnt vmcnt(11)
    v_mfma_f32_32x32x16_bf16 v[36:51], a[48:51], v[148:151], v[36:51]
    v_mfma_f32_32x32x16_bf16 v[52:67], a[52:55], v[148:151], v[52:67]
    s_waitcnt vmcnt(10)
    v_mfma_f32_32x32x16_bf16 v[68:83], a[48:51], v[152:155], v[68:83]
    v_mfma_f32_32x32x16_bf16 v[84:99], a[52:55], v[152:155], v[84:99]
    s_lshl_b32 s56, s49, 11
    s_add_u32 s56, s56, s54
    s_add_u32 s49, s49, 1
    s_cmp_eq_u32 s49, 14
    s_cselect_b32 s49, 0, s49
    buffer_load_dwordx4 v[148:151], v255, s[28:31], s56 offen offset:0 sc1
    buffer_load_dwordx4 v[152:155], v254, s[28:31], s56 offen offset:0 sc1
    s_waitcnt vmcnt(11)
    v_mfma_f32_32x32x16_bf16 v[36:51], a[56:59], v[156:159], v[36:51]
    v_mfma_f32_32x32x16_bf16 v[52:67], a[60:63], v[156:159], v[52:67]
    s_waitcnt vmcnt(10)
    v_mfma_f32_32x32x16_bf16 v[68:83], a[56:59], v[160:163], v[68:83]
    v_mfma_f32_32x32x16_bf16 v[84:99], a[60:63], v[160:163], v[84:99]
    buffer_load_dwordx4 v[156:159], v255, s[28:31], s56 offen offset:1024 sc1
    buffer_load_dwordx4 v[160:163], v254, s[28:31], s56 offen offset:1024 sc1
    s_waitcnt vmcnt(11)
    v_mfma_f32_32x32x16_bf16 v[36:51], a[64:67], v[164:167], v[36:51]
    v_mfma_f32_32x32x16_bf16 v[52:67], a[68:71], v[164:167], v[52:67]
    s_waitcnt vmcnt(10)
    v_mfma_f32_32x32x16_bf16 v[68:83], a[64:67], v[168:171], v[68:83]
    v_mfma_f32_32x32x16_bf16 v[84:99], a[68:71], v[168:171], v[84:99]
    s_lshl_b32 s56, s49, 11
    s_add_u32 s56, s56, s54
    s_add_u32 s49, s49, 1
    s_cmp_eq_u32 s49, 14
    s_cselect_b32 s49, 0, s49
    buffer_load_dwordx4 v[164:167], v255, s[28:31], s56 offen offset:0 sc1
    buffer_load_dwordx4 v[168:171], v254, s[28:31], s56 offen offset:0 sc1
    s_waitcnt vmcnt(11)
    v_mfma_f32_32x32x16_bf16 v[36:51], a[72:75], v[172:175], v[36:51]
    v_mfma_f32_32x32x16_bf16 v[52:67], a[76:79], v[172:175], v[52:67]
    s_waitcnt vmcnt(10)
    v_mfma_f32_32x32x16_bf16 v[68:83], a[72:75], v[184:187], v[68:83]
    v_mfma_f32_32x32x16_bf16 v[84:99], a[76:79], v[184:187], v[84:99]
    buffer_load_dwordx4 v[172:175], v255, s[28:31], s56 offen offset:1024 sc1
    buffer_load_dwordx4 v[184:187], v254, s[28:31], s56 offen offset:1024 sc1
    s_waitcnt vmcnt(11)
    v_mfma_f32_32x32x16_bf16 v[36:51], a[80:83], v[188:191], v[36:51]
    v_mfma_f32_32x32x16_bf16 v[52:67], a[84:87], v[188:191], v[52:67]
    s_waitcnt vmcnt(10)
    v_mfma_f32_32x32x16_bf16 v[68:83], a[80:83], v[192:195], v[68:83]
    v_mfma_f32_32x32x16_bf16 v[84:99], a[84:87], v[192:195], v[84:99]
    s_lshl_b32 s56, s49, 11
    s_add_u32 s56, s56, s54
    s_add_u32 s49, s49, 1
    s_cmp_eq_u32 s49, 14
    s_cselect_b32 s49, 0, s49
    buffer_load_dwordx4 v[188:191], v255, s[28:31], s56 offen offset:0 sc1
    buffer_load_dwordx4 v[192:195], v254, s[28:31], s56 offen offset:0 sc1
    s_waitcnt vmcnt(11)
    v_mfma_f32_32x32x16_bf16 v[36:51], a[88:91], v[196:199], v[36:51]
    v_mfma_f32_32x32x16_bf16 v[52:67], a[92:95], v[196:199], v[52:67]
    s_waitcnt vmcnt(10)
    v_mfma_f32_32x32x16_bf16 v[68:83], a[88:91], v[200:203], v[68:83]
    v_mfma_f32_32x32x16_bf16 v[84:99], a[92:95], v[200:203], v[84:99]
    buffer_load_dwordx4 v[196:199], v255, s[28:31], s56 offen offset:1024 sc1
    buffer_load_dwordx4 v[200:203], v254, s[28:31], s56 offen offset:1024 sc1
    s_waitcnt vmcnt(11)
    v_mfma_f32_32x32x16_bf16 v[36:51], a[96:99], v[148:151], v[36:51]
    v_mfma_f32_32x32x16_bf16 v[52:67], a[100:103], v[148:151], v[52:67]
    s_waitcnt vmcnt(10)
    v_mfma_f32_32x32x16_bf16 v[68:83], a[96:99], v[152:155], v[68:83]
    v_mfma_f32_32x32x16_bf16 v[84:99], a[100:103], v[152:155], v[84:99]
    s_lshl_b32 s56, s49, 11
    s_add_u32 s56, s56, s54
    s_add_u32 s49, s49, 1
    s_cmp_eq_u32 s49, 14
    s_cselect_b32 s49, 0, s49
    buffer_load_dwordx4 v[148:151], v255, s[28:31], s56 offen offset:0 sc1
    buffer_load_dwordx4 v[152:155], v254, s[28:31], s56 offen offset:0 sc1
    s_waitcnt vmcnt(11)
    v_mfma_f32_32x32x16_bf16 v[36:51], a[104:107], v[156:159], v[36:51]
    v_mfma_f32_32x32x16_bf16 v[52:67], a[108:111], v[156:159], v[52:67]
    s_waitcnt vmcnt(10)
    v_mfma_f32_32x32x16_bf16 v[68:83], a[104:107], v[160:163], v[68:83]
    v_mfma_f32_32x32x16_bf16 v[84:99], a[108:111], v[160:163], v[84:99]
    buffer_load_dwordx4 v[156:159], v255, s[28:31], s56 offen offset:1024 sc1
    buffer_load_dwordx4 v[160:163], v254, s[28:31], s56 offen offset:1024 sc1
    s_waitcnt vmcnt(11)
    v_mfma_f32_32x32x16_bf16 v[36:51], a[112:115], v[164:167], v[36:51]
    v_mfma_f32_32x32x16_bf16 v[52:67], a[116:119], v[164:167], v[52:67]
    s_waitcnt vmcnt(10)
    v_mfma_f32_32x32x16_bf16 v[68:83], a[112:115], v[168:171], v[68:83]
    v_mfma_f32_32x32x16_bf16 v[84:99], a[116:119], v[168:171], v[84:99]
    s_mul_i32 s57, s6, 3584
    s_add_u32 s57, s57, 11272192
    buffer_load_dword v249, v250, s[28:31], s57 offen sc1
    s_lshl_b32 s56, s49, 11
    s_add_u32 s56, s56, s54
    s_add_u32 s49, s49, 1
    s_cmp_eq_u32 s49, 14
    s_cselect_b32 s49, 0, s49
    buffer_load_dwordx4 v[164:167], v255, s[28:31], s56 offen offset:0 sc1
    buffer_load_dwordx4 v[168:171], v254, s[28:31], s56 offen offset:0 sc1
    s_waitcnt vmcnt(12)
    v_mfma_f32_32x32x16_bf16 v[36:51], a[120:123], v[172:175], v[36:51]
    v_mfma_f32_32x32x16_bf16 v[52:67], a[124:127], v[172:175], v[52:67]
    s_waitcnt vmcnt(11)
    v_mfma_f32_32x32x16_bf16 v[68:83], a[120:123], v[184:187], v[68:83]
    v_mfma_f32_32x32x16_bf16 v[84:99], a[124:127], v[184:187], v[84:99]
    buffer_load_dwordx4 v[172:175], v255, s[28:31], s56 offen offset:1024 sc1
    buffer_load_dwordx4 v[184:187], v254, s[28:31], s56 offen offset:1024 sc1
    s_waitcnt vmcnt(12)
    v_mfma_f32_32x32x16_bf16 v[36:51], a[128:131], v[188:191], v[36:51]
    v_mfma_f32_32x32x16_bf16 v[52:67], a[132:135], v[188:191], v[52:67]
    s_waitcnt vmcnt(11)
    v_mfma_f32_32x32x16_bf16 v[68:83], a[128:131], v[192:195], v[68:83]
    v_mfma_f32_32x32x16_bf16 v[84:99], a[132:135], v[192:195], v[84:99]
    s_lshl_b32 s56, s49, 11
    s_add_u32 s56, s56, s54
    s_add_u32 s49, s49, 1
    s_cmp_eq_u32 s49, 14
    s_cselect_b32 s49, 0, s49
    buffer_load_dwordx4 v[188:191], v255, s[28:31], s56 offen offset:0 sc1
    buffer_load_dwordx4 v[192:195], v254, s[28:31], s56 offen offset:0 sc1
    s_waitcnt vmcnt(12)
    v_mfma_f32_32x32x16_bf16 v[36:51], a[136:139], v[196:199], v[36:51]
    v_mfma_f32_32x32x16_bf16 v[52:67], a[140:143], v[196:199], v[52:67]
    s_waitcnt vmcnt(11)
    v_mfma_f32_32x32x16_bf16 v[68:83], a[136:139], v[200:203], v[68:83]
    v_mfma_f32_32x32x16_bf16 v[84:99], a[140:143], v[200:203], v[84:99]
    buffer_load_dwordx4 v[196:199], v255, s[28:31], s56 offen offset:1024 sc1
    buffer_load_dwordx4 v[200:203], v254, s[28:31], s56 offen offset:1024 sc1
    s_waitcnt vmcnt(12)
    v_mfma_f32_32x32x16_bf16 v[36:51], a[144:147], v[148:151], v[36:51]
    v_mfma_f32_32x32x16_bf16 v[52:67], a[148:151], v[148:151], v[52:67]
    s_waitcnt vmcnt(11)
    v_mfma_f32_32x32x16_bf16 v[68:83], a[144:147], v[152:155], v[68:83]
    v_mfma_f32_32x32x16_bf16 v[84:99], a[148:151], v[152:155], v[84:99]
    s_lshl_b32 s56, s49, 11
    s_add_u32 s56, s56, s54
    s_add_u32 s49, s49, 1
    s_cmp_eq_u32 s49, 14
    s_cselect_b32 s49, 0, s49
    buffer_load_dwordx4 v[148:151], v255, s[28:31], s56 offen offset:0 sc1
    buffer_load_dwordx4 v[152:155], v254, s[28:31], s56 offen offset:0 sc1
    s_waitcnt vmcnt(12)
    v_mfma_f32_32x32x16_bf16 v[36:51], a[152:155], v[156:159], v[36:51]
    v_mfma_f32_32x32x16_bf16 v[52:67], a[156:159], v[156:159], v[52:67]
    s_waitcnt vmcnt(11)
    v_mfma_f32_32x32x16_bf16 v[68:83], a[152:155], v[160:163], v[68:83]
    v_mfma_f32_32x32x16_bf16 v[84:99], a[156:159], v[160:163], v[84:99]
    buffer_load_dwordx4 v[156:159], v255, s[28:31], s56 offen offset:1024 sc1
    buffer_load_dwordx4 v[160:163], v254, s[28:31], s56 offen offset:1024 sc1
    s_waitcnt vmcnt(11)
    v_mfma_f32_32x32x16_bf16 v[36:51], a[160:163], v[164:167], v[36:51]
    v_mfma_f32_32x32x16_bf16 v[52:67], a[164:167], v[164:167], v[52:67]
    s_waitcnt vmcnt(10)
    v_mfma_f32_32x32x16_bf16 v[68:83], a[160:163], v[168:171], v[68:83]
    v_mfma_f32_32x32x16_bf16 v[84:99], a[164:167], v[168:171], v[84:99]
    s_lshl_b32 s56, s49, 11
    s_add_u32 s56, s56, s54
    s_add_u32 s49, s49, 1
    s_cmp_eq_u32 s49, 14
    s_cselect_b32 s49, 0, s49
    buffer_load_dwordx4 v[164:167], v255, s[28:31], s56 offen offset:0 sc1
    buffer_load_dwordx4 v[168:171], v254, s[28:31], s56 offen offset:0 sc1
    s_waitcnt vmcnt(11)
    v_mfma_f32_32x32x16_bf16 v[36:51], a[168:171], v[172:175], v[36:51]
    v_mfma_f32_32x32x16_bf16 v[52:67], a[172:175], v[172:175], v[52:67]
    s_waitcnt vmcnt(10)
    v_mfma_f32_32x32x16_bf16 v[68:83], a[168:171], v[184:187], v[68:83]
    v_mfma_f32_32x32x16_bf16 v[84:99], a[172:175], v[184:187], v[84:99]
    buffer_load_dwordx4 v[172:175], v255, s[28:31], s56 offen offset:1024 sc1
    buffer_load_dwordx4 v[184:187], v254, s[28:31], s56 offen offset:1024 sc1
    s_waitcnt vmcnt(11)
    v_mfma_f32_32x32x16_bf16 v[36:51], a[176:179], v[188:191], v[36:51]
    v_mfma_f32_32x32x16_bf16 v[52:67], a[180:183], v[188:191], v[52:67]
    s_waitcnt vmcnt(10)
    v_mfma_f32_32x32x16_bf16 v[68:83], a[176:179], v[192:195], v[68:83]
    v_mfma_f32_32x32x16_bf16 v[84:99], a[180:183], v[192:195], v[84:99]
    s_mov_b32 s84, 0
L_ps_chk:
    v_cmp_ne_u32 vcc, s96, v249
    s_nop 1
    s_and_b64 vcc, vcc, s[52:53]
    s_nop 1
    s_cbranch_vccz L_ps_ok
    s_add_u32 s84, s84, 1
    s_cmp_gt_u32 s84, 0x8000
    s_cbranch_scc1 L_ps_ok
    s_sleep 1
    buffer_load_dword v249, v250, s[28:31], s57 offen sc1
    s_waitcnt vmcnt(0)
    s_branch L_ps_chk
L_ps_ok:
    s_cmp_eq_u32 s6, 31
    s_cselect_b32 s84, 0, 1
    s_or_b32 s84, s84, s7
    s_or_b32 s84, s84, s3
    s_mov_b32 s85, 33554432
    s_cmp_eq_u32 s84, 0
    s_cselect_b32 s84, 11386880, s85
    s_add_u32 s85, s97, 1
    v_mov_b32 v247, s85
    v_cmp_eq_u32 vcc, 0, v1
    v_mov_b32 v246, 33554432
    s_nop 0
    v_cndmask_b32 v246, v246, 0, vcc
    buffer_store_dword v247, v246, s[28:31], s84 offen sc1
    s_and_b32 s78, s3, 1
    s_lshl_b32 s78, s78, 2
    s_add_u32 s78, s78, s50
    s_add_u32 s50, s50, 1
    s_cmp_eq_u32 s50, 3
    s_cselect_b32 s50, 0, s50
    s_lshl_b32 s78, s78, 12
    s_add_u32 s78, s78, s55
    s_and_b32 s56, s3, 1
    s_lshl_b32 s56, s56, 11
    s_add_u32 s56, s56, s78
    buffer_load_dwordx4 v[188:191], v253, s[28:31], s56 offen offset:0 sc1
    buffer_load_dwordx4 v[192:195], v252, s[28:31], s56 offen offset:0 sc1
    s_waitcnt vmcnt(12)
    v_mfma_f32_32x32x16_bf16 v[36:51], a[184:187], v[196:199], v[36:51]
    v_mfma_f32_32x32x16_bf16 v[52:67], a[188:191], v[196:199], v[52:67]
    s_waitcnt vmcnt(11)
    v_mfma_f32_32x32x16_bf16 v[68:83], a[184:187], v[200:203], v[68:83]
    v_mfma_f32_32x32x16_bf16 v[84:99], a[188:191], v[200:203], v[84:99]
    buffer_load_dwordx4 v[196:199], v253, s[28:31], s56 offen offset:1024 sc1
    buffer_load_dwordx4 v[200:203], v252, s[28:31], s56 offen offset:1024 sc1
    s_waitcnt vmcnt(12)
    v_mfma_f32_32x32x16_bf16 v[36:51], a[192:195], v[148:151], v[36:51]
    v_mfma_f32_32x32x16_bf16 v[52:67], a[196:199], v[148:151], v[52:67]
    s_waitcnt vmcnt(11)
    v_mfma_f32_32x32x16_bf16 v[68:83], a[192:195], v[152:155], v[68:83]
    v_mfma_f32_32x32x16_bf16 v[84:99], a[196:199], v[152:155], v[84:99]
    s_xor_b32 s56, s56, 2048
    buffer_load_dwordx4 v[148:151], v253, s[28:31], s56 offen offset:0 sc1
    buffer_load_dwordx4 v[152:155], v252, s[28:31], s56 offen offset:0 sc1
    s_waitcnt vmcnt(12)
    v_mfma_f32_32x32x16_bf16 v[36:51], a[200:203], v[156:159], v[36:51]
    v_mfma_f32_32x32x16_bf16 v[52:67], a[204:207], v[156:159], v[52:67]
    s_waitcnt vmcnt(11)
    v_mfma_f32_32x32x16_bf16 v[68:83], a[200:203], v[160:163], v[68:83]
    v_mfma_f32_32x32x16_bf16 v[84:99], a[204:207], v[160:163], v[84:99]
    buffer_load_dwordx4 v[156:159], v253, s[28:31], s56 offen offset:1024 sc1
    buffer_load_dwordx4 v[160:163], v252, s[28:31], s56 offen offset:1024 sc1
    s_waitcnt vmcnt(12)
    v_mfma_f32_32x32x16_bf16 v[36:51], a[208:211], v[164:167], v[36:51]
    v_mfma_f32_32x32x16_bf16 v[52:67], a[212:215], v[164:167], v[52:67]
    s_waitcnt vmcnt(11)
    v_mfma_f32_32x32x16_bf16 v[68:83], a[208:211], v[168:171], v[68:83]
    v_mfma_f32_32x32x16_bf16 v[84:99], a[212:215], v[168:171], v[84:99]
    s_and_b32 s78, s3, 1
    s_lshl_b32 s78, s78, 2
    s_add_u32 s78, s78, s50
    s_add_u32 s50, s50, 1
    s_cmp_eq_u32 s50, 3
    s_cselect_b32 s50, 0, s50
    s_lshl_b32 s78, s78, 12
    s_add_u32 s78, s78, s55
    s_and_b32 s56, s3, 1
    s_lshl_b32 s56, s56, 11
    s_add_u32 s56, s56, s78
    buffer_load_dwordx4 v[164:167], v253, s[28:31], s56 offen offset:0 sc1
    buffer_load_dwordx4 v[168:171], v252, s[28:31], s56 offen offset:0 sc1
    s_waitcnt vmcnt(12)
    v_mfma_f32_32x32x16_bf16 v[36:51], a[216:219], v[172:175], v[36:51]
    v_mfma_f32_32x32x16_bf16 v[52:67], a[220:223], v[172:175], v[52:67]
    s_waitcnt vmcnt(11)
    v_mfma_f32_32x32x16_bf16 v[68:83], a[216:219], v[184:187], v[68:83]
    v_mfma_f32_32x32x16_bf16 v[84:99], a[220:223], v[184:187], v[84:99]
    buffer_load_dwordx4 v[172:175], v253, s[28:31], s56 offen offset:1024 sc1
    buffer_load_dwordx4 v[184:187], v252, s[28:31], s56 offen offset:1024 sc1
    s_waitcnt vmcnt(11)
    v_mfma_f32_32x32x16_bf16 v[20:35], a[224:227], v[188:191], v[20:35]
    v_mfma_f32_32x32x16_bf16 v[100:115], a[228:231], v[188:191], 0
    s_waitcnt vmcnt(10)
    v_mfma_f32_32x32x16_bf16 v[116:131], a[224:227], v[192:195], 0
    v_mfma_f32_32x32x16_bf16 v[132:147], a[228:231], v[192:195], 0
    s_xor_b32 s56, s56, 2048
    buffer_load_dwordx4 v[188:191], v253, s[28:31], s56 offen offset:0 sc1
    buffer_load_dwordx4 v[192:195], v252, s[28:31], s56 offen offset:0 sc1
    s_waitcnt vmcnt(11)
    v_mfma_f32_32x32x16_bf16 v[20:35], a[232:235], v[196:199], v[20:35]
    v_mfma_f32_32x32x16_bf16 v[100:115], a[236:239], v[196:199], v[100:115]
    v_add_u32 v247, s44, v248
    ds_write_b128 v247, v[52:55] offset:16384
    ds_write_b128 v247, v[56:59] offset:17408
    ds_write_b128 v247, v[60:63] offset:18432
    ds_write_b128 v247, v[64:67] offset:19456
    ds_write_b128 v247, v[68:71] offset:20480
    ds_write_b128 v247, v[72:75] offset:21504
    ds_write_b128 v247, v[76:79] offset:22528
    s_waitcnt vmcnt(10)
    v_mfma_f32_32x32x16_bf16 v[116:131], a[232:235], v[200:203], v[116:131]
    ds_write_b128 v247, v[80:83] offset:23552
    ds_write_b128 v247, v[84:87] offset:24576
    ds_write_b128 v247, v[88:91] offset:25600
    ds_write_b128 v247, v[92:95] offset:26624
    ds_write_b128 v247, v[96:99] offset:27648
    v_mfma_f32_32x32x16_bf16 v[132:147], a[236:239], v[200:203], v[132:147]
    buffer_load_dwordx4 v[196:199], v253, s[28:31], s56 offen offset:1024 sc1
    buffer_load_dwordx4 v[200:203], v252, s[28:31], s56 offen offset:1024 sc1
    s_waitcnt vmcnt(11)
    v_mfma_f32_32x32x16_bf16 v[20:35], a[240:243], v[148:151], v[20:35]
    v_mfma_f32_32x32x16_bf16 v[100:115], a[244:247], v[148:151], v[100:115]
    s_waitcnt vmcnt(10)
    v_mfma_f32_32x32x16_bf16 v[116:131], a[240:243], v[152:155], v[116:131]
    v_mfma_f32_32x32x16_bf16 v[132:147], a[244:247], v[152:155], v[132:147]
    s_and_b32 s78, s3, 1
    s_lshl_b32 s78, s78, 2
    s_add_u32 s78, s78, s50
    s_add_u32 s50, s50, 1
    s_cmp_eq_u32 s50, 3
    s_cselect_b32 s50, 0, s50
    s_lshl_b32 s78, s78, 12
    s_add_u32 s78, s78, s55
    s_and_b32 s56, s3, 1
    s_lshl_b32 s56, s56, 11
    s_add_u32 s56, s56, s78
    buffer_load_dwordx4 v[148:151], v253, s[28:31], s56 offen offset:0 sc1
    buffer_load_dwordx4 v[152:155], v252, s[28:31], s56 offen offset:0 sc1
    s_waitcnt vmcnt(11)
    v_mfma_f32_32x32x16_bf16 v[20:35], a[248:251], v[156:159], v[20:35]
    ds_read_b128 v[204:207], v183 offset:28672
    ds_read_b128 v[208:211], v182 offset:28672
    v_mfma_f32_32x32x16_bf16 v[100:115], a[252:255], v[156:159], v[100:115]
    s_waitcnt vmcnt(10)
    v_mfma_f32_32x32x16_bf16 v[116:131], a[248:251], v[160:163], v[116:131]
    v_mfma_f32_32x32x16_bf16 v[132:147], a[252:255], v[160:163], v[132:147]
    buffer_load_dwordx4 v[156:159], v253, s[28:31], s56 offen offset:1024 sc1
    buffer_load_dwordx4 v[160:163], v252, s[28:31], s56 offen offset:1024 sc1
    s_waitcnt vmcnt(11) lgkmcnt(1)
    v_mfma_f32_32x32x16_bf16 v[20:35], v[204:207], v[164:167], v[20:35]
    ds_read_b128 v[212:215], v181 offset:28672
    ds_read_b128 v[216:219], v180 offset:28672
    s_waitcnt lgkmcnt(2)
    v_mfma_f32_32x32x16_bf16 v[100:115], v[208:211], v[164:167], v[100:115]
    s_waitcnt lgkmcnt(0)
    s_barrier
    s_xor_b32 s84, s3, 1
    s_mul_i32 s84, s84, 36864
    v_add_u32 v247, s84, v248
    ds_read_b128 v[52:55], v247 offset:16384
    ds_read_b128 v[56:59], v247 offset:17408
    ds_read_b128 v[60:63], v247 offset:18432
    ds_read_b128 v[64:67], v247 offset:19456
    s_waitcnt vmcnt(10)
    v_mfma_f32_32x32x16_bf16 v[116:131], v[204:207], v[168:171], v[116:131]
    s_xor_b32 s84, s3, 2
    s_mul_i32 s84, s84, 36864
    v_add_u32 v247, s84, v248
    ds_read_b128 v[68:71], v247 offset:20480
    ds_read_b128 v[72:75], v247 offset:21504
    ds_read_b128 v[76:79], v247 offset:22528
    ds_read_b128 v[80:83], v247 offset:23552
    s_xor_b32 s84, s3, 3
    v_mfma_f32_32x32x16_bf16 v[132:147], v[208:211], v[168:171], v[132:147]
    s_xor_b32 s56, s56, 2048
    buffer_load_dwordx4 v[164:167], v253, s[28:31], s56 offen offset:0 sc1
    buffer_load_dwordx4 v[168:171], v252, s[28:31], s56 offen offset:0 sc1
    s_waitcnt vmcnt(11)
    v_mfma_f32_32x32x16_bf16 v[20:35], v[212:215], v[172:175], v[20:35]
    ds_read_b128 v[204:207], v179 offset:28672
    ds_read_b128 v[208:211], v178 offset:28672
    v_mfma_f32_32x32x16_bf16 v[100:115], v[216:219], v[172:175], v[100:115]
    s_mul_i32 s84, s84, 36864
    v_add_u32 v247, s84, v248
    ds_read_b128 v[84:87], v247 offset:24576
    ds_read_b128 v[88:91], v247 offset:25600
    ds_read_b128 v[92:95], v247 offset:26624
    ds_read_b128 v[96:99], v247 offset:27648
    s_waitcnt lgkmcnt(13)
    v_add_f32 v36, v36, v52
    v_add_f32 v37, v37, v53
    s_waitcnt vmcnt(10)
    v_mfma_f32_32x32x16_bf16 v[116:131], v[212:215], v[184:187], v[116:131]
    v_add_f32 v38, v38, v54
    v_add_f32 v39, v39, v55
    s_waitcnt lgkmcnt(12)
    v_add_f32 v40, v40, v56
    v_add_f32 v41, v41, v57
    v_add_f32 v42, v42, v58
    v_add_f32 v43, v43, v59
    s_waitcnt lgkmcnt(11)
    v_add_f32 v44, v44, v60
    v_add_f32 v45, v45, v61
    v_mfma_f32_32x32x16_bf16 v[132:147], v[216:219], v[184:187], v[132:147]
    buffer_load_dwordx4 v[172:175], v253, s[28:31], s56 offen offset:1024 sc1
    buffer_load_dwordx4 v[184:187], v252, s[28:31], s56 offen offset:1024 sc1
    s_waitcnt vmcnt(11) lgkmcnt(5)
    v_mfma_f32_32x32x16_bf16 v[20:35], v[204:207], v[188:191], v[20:35]
    ds_read_b128 v[212:215], v177 offset:28672
    ds_read_b128 v[216:219], v176 offset:28672
    s_waitcnt lgkmcnt(6)
    v_mfma_f32_32x32x16_bf16 v[100:115], v[208:211], v[188:191], v[100:115]
    v_add_f32 v46, v46, v62
    v_add_f32 v47, v47, v63
    v_add_f32 v48, v48, v64
    v_add_f32 v49, v49, v65
    v_add_f32 v50, v50, v66
    v_add_f32 v51, v51, v67
    v_add_f32 v36, v36, v68
    v_add_f32 v37, v37, v69
    s_waitcnt vmcnt(10)
    v_mfma_f32_32x32x16_bf16 v[116:131], v[204:207], v[192:195], v[116:131]
    v_add_f32 v38, v38, v70
    v_add_f32 v39, v39, v71
    v_add_f32 v40, v40, v72
    v_add_f32 v41, v41, v73
    v_add_f32 v42, v42, v74
    v_add_f32 v43, v43, v75
    v_add_f32 v44, v44, v76
    v_add_f32 v45, v45, v77
    v_mfma_f32_32x32x16_bf16 v[132:147], v[208:211], v[192:195], v[132:147]
    s_mov_b32 s78, 3
    s_lshl_b32 s78, s78, 12
    s_add_u32 s78, s78, s55
    s_and_b32 s56, s3, 1
    s_lshl_b32 s56, s56, 11
    s_add_u32 s56, s56, s78
    buffer_load_dwordx4 v[188:191], v253, s[28:31], s56 offen offset:0 sc1
    buffer_load_dwordx4 v[192:195], v252, s[28:31], s56 offen offset:0 sc1
    s_waitcnt vmcnt(11) lgkmcnt(1)
    v_mfma_f32_32x32x16_bf16 v[20:35], v[212:215], v[196:199], v[20:35]
    ds_read_b128 v[204:207], v183 offset:0
    ds_read_b128 v[208:211], v182 offset:0
    s_waitcnt lgkmcnt(2)
    v_mfma_f32_32x32x16_bf16 v[100:115], v[216:219], v[196:199], v[100:115]
    v_add_f32 v46, v46, v78
    v_add_f32 v47, v47, v79
    v_add_f32 v48, v48, v80
    v_add_f32 v49, v49, v81
    v_add_f32 v50, v50, v82
    v_add_f32 v51, v51, v83
    v_add_f32 v36, v36, v84
    v_add_f32 v37, v37, v85
    s_waitcnt vmcnt(10)
    v_mfma_f32_32x32x16_bf16 v[116:131], v[212:215], v[200:203], v[116:131]
    v_add_f32 v38, v38, v86
    v_add_f32 v39, v39, v87
    v_add_f32 v40, v40, v88
    v_add_f32 v41, v41, v89
    v_add_f32 v42, v42, v90
    v_add_f32 v43, v43, v91
    v_add_f32 v44, v44, v92
    v_add_f32 v45, v45, v93
    v_mfma_f32_32x32x16_bf16 v[132:147], v[216:219], v[200:203], v[132:147]
    buffer_load_dwordx4 v[196:199], v253, s[28:31], s56 offen offset:1024 sc1
    buffer_load_dwordx4 v[200:203], v252, s[28:31], s56 offen offset:1024 sc1
    s_waitcnt vmcnt(11) lgkmcnt(1)
    v_mfma_f32_32x32x16_bf16 v[20:35], v[204:207], v[148:151], v[20:35]
    ds_read_b128 v[212:215], v181 offset:0
    ds_read_b128 v[216:219], v180 offset:0
    s_waitcnt lgkmcnt(2)
    v_mfma_f32_32x32x16_bf16 v[100:115], v[208:211], v[148:151], v[100:115]
    v_add_f32 v46, v46, v94
    v_add_f32 v47, v47, v95
    v_add_f32 v48, v48, v96
    v_add_f32 v49, v49, v97
    v_add_f32 v50, v50, v98
    v_add_f32 v51, v51, v99
    v_mul_f32 v52, 0xbfb8aa3b, v36
    v_mul_f32 v53, 0xbfb8aa3b, v37
    s_waitcnt vmcnt(10)
    v_mfma_f32_32x32x16_bf16 v[116:131], v[204:207], v[152:155], v[116:131]
    v_mul_f32 v54, 0xbfb8aa3b, v38
    v_mul_f32 v55, 0xbfb8aa3b, v39
    v_mul_f32 v56, 0xbfb8aa3b, v40
    v_mul_f32 v57, 0xbfb8aa3b, v41
    v_mul_f32 v58, 0xbfb8aa3b, v42
    v_mul_f32 v59, 0xbfb8aa3b, v43
    v_mul_f32 v60, 0xbfb8aa3b, v44
    v_mul_f32 v61, 0xbfb8aa3b, v45
    v_mfma_f32_32x32x16_bf16 v[132:147], v[208:211], v[152:155], v[132:147]
    s_waitcnt vmcnt(9) lgkmcnt(1)
    v_mfma_f32_32x32x16_bf16 v[20:35], v[212:215], v[156:159], v[20:35]
    ds_read_b128 v[204:207], v179 offset:0
    ds_read_b128 v[208:211], v178 offset:0
    s_waitcnt lgkmcnt(2)
    v_mfma_f32_32x32x16_bf16 v[100:115], v[216:219], v[156:159], v[100:115]
    v_mul_f32 v62, 0xbfb8aa3b, v46
    v_mul_f32 v63, 0xbfb8aa3b, v47
    v_mul_f32 v64, 0xbfb8aa3b, v48
    v_mul_f32 v65, 0xbfb8aa3b, v49
    v_mul_f32 v66, 0xbfb8aa3b, v50
    v_mul_f32 v67, 0xbfb8aa3b, v51
    v_exp_f32 v52, v52
    v_exp_f32 v53, v53
    s_waitcnt vmcnt(8)
    v_mfma_f32_32x32x16_bf16 v[116:131], v[212:215], v[160:163], v[116:131]
    v_exp_f32 v54, v54
    v_exp_f32 v55, v55
    v_exp_f32 v56, v56
    v_exp_f32 v57, v57
    v_exp_f32 v58, v58
    v_exp_f32 v59, v59
    v_exp_f32 v60, v60
    v_exp_f32 v61, v61
    v_mfma_f32_32x32x16_bf16 v[132:147], v[216:219], v[160:163], v[132:147]
    s_waitcnt vmcnt(7) lgkmcnt(1)
    v_mfma_f32_32x32x16_bf16 v[20:35], v[204:207], v[164:167], v[20:35]
    ds_read_b128 v[212:215], v177 offset:0
    ds_read_b128 v[216:219], v176 offset:0
    s_waitcnt lgkmcnt(2)
    v_mfma_f32_32x32x16_bf16 v[100:115], v[208:211], v[164:167], v[100:115]
    v_exp_f32 v62, v62
    v_exp_f32 v63, v63
    v_exp_f32 v64, v64
    v_exp_f32 v65, v65
    v_exp_f32 v66, v66
    v_exp_f32 v67, v67
    v_add_f32 v52, 1.0, v52
    v_add_f32 v53, 1.0, v53
    s_waitcnt vmcnt(6)
    v_mfma_f32_32x32x16_bf16 v[116:131], v[204:207], v[168:171], v[116:131]
    v_add_f32 v54, 1.0, v54
    v_add_f32 v55, 1.0, v55
    v_add_f32 v56, 1.0, v56
    v_add_f32 v57, 1.0, v57
    v_add_f32 v58, 1.0, v58
    v_add_f32 v59, 1.0, v59
    v_add_f32 v60, 1.0, v60
    v_add_f32 v61, 1.0, v61
    v_mfma_f32_32x32x16_bf16 v[132:147], v[208:211], v[168:171], v[132:147]
    s_waitcnt vmcnt(5) lgkmcnt(1)
    v_mfma_f32_32x32x16_bf16 v[20:35], v[212:215], v[172:175], v[20:35]
    ds_read_b128 v[204:207], v183 offset:8192
    ds_read_b128 v[208:211], v182 offset:8192
    s_waitcnt lgkmcnt(2)
    v_mfma_f32_32x32x16_bf16 v[100:115], v[216:219], v[172:175], v[100:115]
    v_add_f32 v62, 1.0, v62
    v_add_f32 v63, 1.0, v63
    v_add_f32 v64, 1.0, v64
    v_add_f32 v65, 1.0, v65
    v_add_f32 v66, 1.0, v66
    v_add_f32 v67, 1.0, v67
    v_rcp_f32 v52, v52
    v_rcp_f32 v53, v53
    s_waitcnt vmcnt(4)
    v_mfma_f32_32x32x16_bf16 v[116:131], v[212:215], v[184:187], v[116:131]
    v_rcp_f32 v54, v54
    v_rcp_f32 v55, v55
    v_rcp_f32 v56, v56
    v_rcp_f32 v57, v57
    v_rcp_f32 v58, v58
    v_rcp_f32 v59, v59
    v_rcp_f32 v60, v60
    v_rcp_f32 v61, v61
    v_mfma_f32_32x32x16_bf16 v[132:147], v[216:219], v[184:187], v[132:147]
    s_waitcnt vmcnt(3) lgkmcnt(1)
    v_mfma_f32_32x32x16_bf16 v[20:35], v[204:207], v[188:191], v[20:35]
    ds_read_b128 v[212:215], v181 offset:8192
    ds_read_b128 v[216:219], v180 offset:8192
    s_waitcnt lgkmcnt(2)
    v_mfma_f32_32x32x16_bf16 v[100:115], v[208:211], v[188:191], v[100:115]
    v_rcp_f32 v62, v62
    v_rcp_f32 v63, v63
    v_rcp_f32 v64, v64
    v_rcp_f32 v65, v65
    v_rcp_f32 v66, v66
    v_rcp_f32 v67, v67
    v_mul_f32 v36, v36, v52
    v_mul_f32 v37, v37, v53
    s_waitcnt vmcnt(2)
    v_mfma_f32_32x32x16_bf16 v[116:131], v[204:207], v[192:195], v[116:131]
    v_mul_f32 v38, v38, v54
    v_mul_f32 v39, v39, v55
    v_mul_f32 v40, v40, v56
    v_mul_f32 v41, v41, v57
    v_mul_f32 v42, v42, v58
    v_mul_f32 v43, v43, v59
    v_mul_f32 v44, v44, v60
    v_mul_f32 v45, v45, v61
    v_mfma_f32_32x32x16_bf16 v[132:147], v[208:211], v[192:195], v[132:147]
    s_waitcnt vmcnt(1) lgkmcnt(1)
    v_mfma_f32_32x32x16_bf16 v[20:35], v[212:215], v[196:199], v[20:35]
    s_waitcnt lgkmcnt(0)
    v_mfma_f32_32x32x16_bf16 v[100:115], v[216:219], v[196:199], v[100:115]
    v_mul_f32 v46, v46, v62
    v_mul_f32 v47, v47, v63
    v_mul_f32 v48, v48, v64
    v_mul_f32 v49, v49, v65
    v_mul_f32 v50, v50, v66
    v_mul_f32 v51, v51, v67
    s_waitcnt vmcnt(0)
    v_mfma_f32_32x32x16_bf16 v[116:131], v[212:215], v[200:203], v[116:131]
    v_mfma_f32_32x32x16_bf16 v[132:147], v[216:219], v[200:203], v[132:147]
    v_add_u32 v246, s44, v248
    s_nop 1
    ds_write_b128 v246, v[100:103] offset:0
    ds_write_b128 v246, v[104:107] offset:1024
    ds_write_b128 v246, v[108:111] offset:2048
    ds_write_b128 v246, v[112:115] offset:3072
    s_nop 3
    ds_write_b128 v246, v[116:119] offset:4096
    ds_write_b128 v246, v[120:123] offset:5120
    ds_write_b128 v246, v[124:127] offset:6144
    ds_write_b128 v246, v[128:131] offset:7168
    ds_write_b128 v246, v[132:135] offset:8192
    ds_write_b128 v246, v[136:139] offset:9216
    ds_write_b128 v246, v[140:143] offset:10240
    ds_write_b128 v246, v[144:147] offset:11264
    s_waitcnt lgkmcnt(0)
    s_barrier
    s_xor_b32 s84, s3, 1
    s_mul_i32 s84, s84, 36864
    v_add_u32 v246, s84, v248
    ds_read_b128 v[100:103], v246 offset:0
    ds_read_b128 v[104:107], v246 offset:1024
    ds_read_b128 v[108:111], v246 offset:2048
    ds_read_b128 v[112:115], v246 offset:3072
    s_xor_b32 s84, s3, 2
    s_mul_i32 s84, s84, 36864
    v_add_u32 v246, s84, v248
    ds_read_b128 v[116:119], v246 offset:4096
    ds_read_b128 v[120:123], v246 offset:5120
    ds_read_b128 v[124:127], v246 offset:6144
    ds_read_b128 v[128:131], v246 offset:7168
    s_xor_b32 s84, s3, 3
    s_mul_i32 s84, s84, 36864
    v_add_u32 v246, s84, v248
    ds_read_b128 v[132:135], v246 offset:8192
    ds_read_b128 v[136:139], v246 offset:9216
    ds_read_b128 v[140:143], v246 offset:10240
    ds_read_b128 v[144:147], v246 offset:11264
    s_waitcnt lgkmcnt(11)
    v_pk_add_f32 v[20:21], v[20:21], v[100:101]
    v_pk_add_f32 v[22:23], v[22:23], v[102:103]
    s_waitcnt lgkmcnt(10)
    v_pk_add_f32 v[24:25], v[24:25], v[104:105]
    v_pk_add_f32 v[26:27], v[26:27], v[106:107]
    s_waitcnt lgkmcnt(9)
    v_pk_add_f32 v[28:29], v[28:29], v[108:109]
    v_pk_add_f32 v[30:31], v[30:31], v[110:111]
    s_waitcnt lgkmcnt(8)
    v_pk_add_f32 v[32:33], v[32:33], v[112:113]
    v_pk_add_f32 v[34:35], v[34:35], v[114:115]
    s_waitcnt lgkmcnt(7)
    v_pk_add_f32 v[20:21], v[20:21], v[116:117]
    v_pk_add_f32 v[22:23], v[22:23], v[118:119]
    s_waitcnt lgkmcnt(6)
    v_pk_add_f32 v[24:25], v[24:25], v[120:121]
    v_pk_add_f32 v[26:27], v[26:27], v[122:123]
    s_waitcnt lgkmcnt(5)
    v_pk_add_f32 v[28:29], v[28:29], v[124:125]
    v_pk_add_f32 v[30:31], v[30:31], v[126:127]
    s_waitcnt lgkmcnt(4)
    v_pk_add_f32 v[32:33], v[32:33], v[128:129]
    v_pk_add_f32 v[34:35], v[34:35], v[130:131]
    s_waitcnt lgkmcnt(3)
    v_pk_add_f32 v[20:21], v[20:21], v[132:133]
    v_pk_add_f32 v[22:23], v[22:23], v[134:135]
    s_waitcnt lgkmcnt(2)
    v_pk_add_f32 v[24:25], v[24:25], v[136:137]
    v_pk_add_f32 v[26:27], v[26:27], v[138:139]
    s_waitcnt lgkmcnt(1)
    v_pk_add_f32 v[28:29], v[28:29], v[140:141]
    v_pk_add_f32 v[30:31], v[30:31], v[142:143]
    s_waitcnt lgkmcnt(0)
    v_pk_add_f32 v[32:33], v[32:33], v[144:145]
    v_pk_add_f32 v[34:35], v[34:35], v[146:147]
    v_lshlrev_b32 v245, 4, v3
    s_lshl_b32 s84, s59, 2
    v_add_u32 v245, s84, v245
    s_movk_i32 s85, 1792
    v_mul_u32_u24 v244, s85, v251
    v_add_u32 v245, v245, v244
    s_mul_i32 s84, s58, 1792
    v_pk_fma_f32 v[20:21], v[20:21], v[36:37], v[4:5]
    v_pk_fma_f32 v[22:23], v[22:23], v[38:39], v[6:7]
    buffer_store_dwordx4 v[20:23], v245, s[40:43], s84 offen offset:0
    v_pk_fma_f32 v[24:25], v[24:25], v[40:41], v[8:9]
    v_pk_fma_f32 v[26:27], v[26:27], v[42:43], v[10:11]
    buffer_store_dwordx4 v[24:27], v245, s[40:43], s84 offen offset:32
    v_pk_fma_f32 v[28:29], v[28:29], v[44:45], v[12:13]
    v_pk_fma_f32 v[30:31], v[30:31], v[46:47], v[14:15]
    buffer_store_dwordx4 v[28:31], v245, s[40:43], s84 offen offset:64
    v_pk_fma_f32 v[32:33], v[32:33], v[48:49], v[16:17]
    v_pk_fma_f32 v[34:35], v[34:35], v[50:51], v[18:19]
    buffer_store_dwordx4 v[32:35], v245, s[40:43], s84 offen offset:96
L_exit:
    s_endpgm
L_spare:
    s_sub_u32 s80, s2, 224
    s_and_b32 s81, s80, 7
    s_lshr_b32 s80, s80, 3
    s_lshl_b32 s81, s81, 8
    s_lshl_b32 s80, s80, 6
    s_add_u32 s80, s80, s81
    s_lshl_b32 s81, s3, 4
    s_add_u32 s80, s80, s81
    v_lshrrev_b32 v255, 4, v1
    v_and_b32 v254, 15, v1
    s_movk_i32 s85, 896
    v_mul_u32_u24 v253, s85, v255
    v_lshl_add_u32 v253, v254, 4, v253
    v_cmp_gt_u32 vcc, 14, v254
    v_mov_b32 v252, 0x7fff0000
    s_nop 0
    v_cndmask_b32 v253, v252, v253, vcc
    s_waitcnt lgkmcnt(0)
    s_mov_b32 s12, s44
    s_and_b32 s13, s45, 0xffff
    s_mov_b32 s14, 1835008
    s_mov_b32 s15, 0x20000
    s_mov_b32 s28, s76
    s_and_b32 s29, s77, 0xffff
    s_mov_b32 s30, 33554432
    s_mov_b32 s31, 0x20000
    s_mov_b32 s84, 11386880
    s_load_dword s96, s[76:77], s84
    s_mul_i32 s86, s80, 896
    buffer_load_dwordx4 v[4:7], v253, s[12:15], s86 offen offset:0
    buffer_load_dwordx4 v[8:11], v253, s[12:15], s86 offen offset:224
    buffer_load_dwordx4 v[12:15], v253, s[12:15], s86 offen offset:448
    buffer_load_dwordx4 v[16:19], v253, s[12:15], s86 offen offset:672
    s_add_u32 s86, s86, 3584
    buffer_load_dwordx4 v[20:23], v253, s[12:15], s86 offen offset:0
    buffer_load_dwordx4 v[24:27], v253, s[12:15], s86 offen offset:224
    buffer_load_dwordx4 v[28:31], v253, s[12:15], s86 offen offset:448
    buffer_load_dwordx4 v[32:35], v253, s[12:15], s86 offen offset:672
    s_add_u32 s86, s86, 3584
    buffer_load_dwordx4 v[36:39], v253, s[12:15], s86 offen offset:0
    buffer_load_dwordx4 v[40:43], v253, s[12:15], s86 offen offset:224
    buffer_load_dwordx4 v[44:47], v253, s[12:15], s86 offen offset:448
    buffer_load_dwordx4 v[48:51], v253, s[12:15], s86 offen offset:672
    s_add_u32 s86, s86, 3584
    buffer_load_dwordx4 v[52:55], v253, s[12:15], s86 offen offset:0
    buffer_load_dwordx4 v[56:59], v253, s[12:15], s86 offen offset:224
    buffer_load_dwordx4 v[60:63], v253, s[12:15], s86 offen offset:448
    buffer_load_dwordx4 v[64:67], v253, s[12:15], s86 offen offset:672
    s_mov_b32 s95, 0x3f803f80
    v_mov_b32 v246, 0
    v_mov_b32 v245, 0
    v_mov_b32 v244, 0
    v_mov_b32 v243, 0
    v_mov_b32 v242, 0
    v_mov_b32 v241, 0
    v_mov_b32 v240, 0
    v_mov_b32 v239, 0
    s_waitcnt vmcnt(15)
    v_dot2c_f32_bf16 v246, s95, v4
    v_dot2c_f32_bf16 v242, v4, v4
    v_dot2c_f32_bf16 v246, s95, v5
    v_dot2c_f32_bf16 v242, v5, v5
    v_dot2c_f32_bf16 v246, s95, v6
    v_dot2c_f32_bf16 v242, v6, v6
    v_dot2c_f32_bf16 v246, s95, v7
    v_dot2c_f32_bf16 v242, v7, v7
    s_waitcnt vmcnt(14)
    v_dot2c_f32_bf16 v246, s95, v8
    v_dot2c_f32_bf16 v242, v8, v8
    v_dot2c_f32_bf16 v246, s95, v9
    v_dot2c_f32_bf16 v242, v9, v9
    v_dot2c_f32_bf16 v246, s95, v10
    v_dot2c_f32_bf16 v242, v10, v10
    v_dot2c_f32_bf16 v246, s95, v11
    v_dot2c_f32_bf16 v242, v11, v11
    s_waitcnt vmcnt(13)
    v_dot2c_f32_bf16 v246, s95, v12
    v_dot2c_f32_bf16 v242, v12, v12
    v_dot2c_f32_bf16 v246, s95, v13
    v_dot2c_f32_bf16 v242, v13, v13
    v_dot2c_f32_bf16 v246, s95, v14
    v_dot2c_f32_bf16 v242, v14, v14
    v_dot2c_f32_bf16 v246, s95, v15
    v_dot2c_f32_bf16 v242, v15, v15
    s_waitcnt vmcnt(12)
    v_dot2c_f32_bf16 v246, s95, v16
    v_dot2c_f32_bf16 v242, v16, v16
    v_dot2c_f32_bf16 v246, s95, v17
    v_dot2c_f32_bf16 v242, v17, v17
    v_dot2c_f32_bf16 v246, s95, v18
    v_dot2c_f32_bf16 v242, v18, v18
    v_dot2c_f32_bf16 v246, s95, v19
    v_dot2c_f32_bf16 v242, v19, v19
    s_waitcnt vmcnt(11)
    v_dot2c_f32_bf16 v245, s95, v20
    v_dot2c_f32_bf16 v241, v20, v20
    v_dot2c_f32_bf16 v245, s95, v21
    v_dot2c_f32_bf16 v241, v21, v21
    v_dot2c_f32_bf16 v245, s95, v22
    v_dot2c_f32_bf16 v241, v22, v22
    v_dot2c_f32_bf16 v245, s95, v23
    v_dot2c_f32_bf16 v241, v23, v23
    s_waitcnt vmcnt(10)
    v_dot2c_f32_bf16 v245, s95, v24
    v_dot2c_f32_bf16 v241, v24, v24
    v_dot2c_f32_bf16 v245, s95, v25
    v_dot2c_f32_bf16 v241, v25, v25
    v_dot2c_f32_bf16 v245, s95, v26
    v_dot2c_f32_bf16 v241, v26, v26
    v_dot2c_f32_bf16 v245, s95, v27
    v_dot2c_f32_bf16 v241, v27, v27
    s_waitcnt vmcnt(9)
    v_dot2c_f32_bf16 v245, s95, v28
    v_dot2c_f32_bf16 v241, v28, v28
    v_dot2c_f32_bf16 v245, s95, v29
    v_dot2c_f32_bf16 v241, v29, v29
    v_dot2c_f32_bf16 v245, s95, v30
    v_dot2c_f32_bf16 v241, v30, v30
    v_dot2c_f32_bf16 v245, s95, v31
    v_dot2c_f32_bf16 v241, v31, v31
    s_waitcnt vmcnt(8)
    v_dot2c_f32_bf16 v245, s95, v32
    v_dot2c_f32_bf16 v241, v32, v32
    v_dot2c_f32_bf16 v245, s95, v33
    v_dot2c_f32_bf16 v241, v33, v33
    v_dot2c_f32_bf16 v245, s95, v34
    v_dot2c_f32_bf16 v241, v34, v34
    v_dot2c_f32_bf16 v245, s95, v35
    v_dot2c_f32_bf16 v241, v35, v35
    s_waitcnt vmcnt(7)
    v_dot2c_f32_bf16 v244, s95, v36
    v_dot2c_f32_bf16 v240, v36, v36
    v_dot2c_f32_bf16 v244, s95, v37
    v_dot2c_f32_bf16 v240, v37, v37
    v_dot2c_f32_bf16 v244, s95, v38
    v_dot2c_f32_bf16 v240, v38, v38
    v_dot2c_f32_bf16 v244, s95, v39
    v_dot2c_f32_bf16 v240, v39, v39
    s_waitcnt vmcnt(6)
    v_dot2c_f32_bf16 v244, s95, v40
    v_dot2c_f32_bf16 v240, v40, v40
    v_dot2c_f32_bf16 v244, s95, v41
    v_dot2c_f32_bf16 v240, v41, v41
    v_dot2c_f32_bf16 v244, s95, v42
    v_dot2c_f32_bf16 v240, v42, v42
    v_dot2c_f32_bf16 v244, s95, v43
    v_dot2c_f32_bf16 v240, v43, v43
    s_waitcnt vmcnt(5)
    v_dot2c_f32_bf16 v244, s95, v44
    v_dot2c_f32_bf16 v240, v44, v44
    v_dot2c_f32_bf16 v244, s95, v45
    v_dot2c_f32_bf16 v240, v45, v45
    v_dot2c_f32_bf16 v244, s95, v46
    v_dot2c_f32_bf16 v240, v46, v46
    v_dot2c_f32_bf16 v244, s95, v47
    v_dot2c_f32_bf16 v240, v47, v47
    s_waitcnt vmcnt(4)
    v_dot2c_f32_bf16 v244, s95, v48
    v_dot2c_f32_bf16 v240, v48, v48
    v_dot2c_f32_bf16 v244, s95, v49
    v_dot2c_f32_bf16 v240, v49, v49
    v_dot2c_f32_bf16 v244, s95, v50
    v_dot2c_f32_bf16 v240, v50, v50
    v_dot2c_f32_bf16 v244, s95, v51
    v_dot2c_f32_bf16 v240, v51, v51
    s_waitcnt vmcnt(3)
    v_dot2c_f32_bf16 v243, s95, v52
    v_dot2c_f32_bf16 v239, v52, v52
    v_dot2c_f32_bf16 v243, s95, v53
    v_dot2c_f32_bf16 v239, v53, v53
    v_dot2c_f32_bf16 v243, s95, v54
    v_dot2c_f32_bf16 v239, v54, v54
    v_dot2c_f32_bf16 v243, s95, v55
    v_dot2c_f32_bf16 v239, v55, v55
    s_waitcnt vmcnt(2)
    v_dot2c_f32_bf16 v243, s95, v56
    v_dot2c_f32_bf16 v239, v56, v56
    v_dot2c_f32_bf16 v243, s95, v57
    v_dot2c_f32_bf16 v239, v57, v57
    v_dot2c_f32_bf16 v243, s95, v58
    v_dot2c_f32_bf16 v239, v58, v58
    v_dot2c_f32_bf16 v243, s95, v59
    v_dot2c_f32_bf16 v239, v59, v59
    s_waitcnt vmcnt(1)
    v_dot2c_f32_bf16 v243, s95, v60
    v_dot2c_f32_bf16 v239, v60, v60
    v_dot2c_f32_bf16 v243, s95, v61
    v_dot2c_f32_bf16 v239, v61, v61
    v_dot2c_f32_bf16 v243, s95, v62
    v_dot2c_f32_bf16 v239, v62, v62
    v_dot2c_f32_bf16 v243, s95, v63
    v_dot2c_f32_bf16 v239, v63, v63
    s_waitcnt vmcnt(0)
    v_dot2c_f32_bf16 v243, s95, v64
    v_dot2c_f32_bf16 v239, v64, v64
    v_dot2c_f32_bf16 v243, s95, v65
    v_dot2c_f32_bf16 v239, v65, v65
    v_dot2c_f32_bf16 v243, s95, v66
    v_dot2c_f32_bf16 v239, v66, v66
    v_dot2c_f32_bf16 v243, s95, v67
    v_dot2c_f32_bf16 v239, v67, v67
    v_add_f32_dpp v246, v246, v246 row_ror:8 row_mask:0xf bank_mask:0xf
    v_add_f32_dpp v245, v245, v245 row_ror:8 row_mask:0xf bank_mask:0xf
    v_add_f32_dpp v244, v244, v244 row_ror:8 row_mask:0xf bank_mask:0xf
    v_add_f32_dpp v243, v243, v243 row_ror:8 row_mask:0xf bank_mask:0xf
    v_add_f32_dpp v242, v242, v242 row_ror:8 row_mask:0xf bank_mask:0xf
    v_add_f32_dpp v241, v241, v241 row_ror:8 row_mask:0xf bank_mask:0xf
    v_add_f32_dpp v240, v240, v240 row_ror:8 row_mask:0xf bank_mask:0xf
    v_add_f32_dpp v239, v239, v239 row_ror:8 row_mask:0xf bank_mask:0xf
    v_add_f32_dpp v246, v246, v246 row_ror:4 row_mask:0xf bank_mask:0xf
    v_add_f32_dpp v245, v245, v245 row_ror:4 row_mask:0xf bank_mask:0xf
    v_add_f32_dpp v244, v244, v244 row_ror:4 row_mask:0xf bank_mask:0xf
    v_add_f32_dpp v243, v243, v243 row_ror:4 row_mask:0xf bank_mask:0xf
    v_add_f32_dpp v242, v242, v242 row_ror:4 row_mask:0xf bank_mask:0xf
    v_add_f32_dpp v241, v241, v241 row_ror:4 row_mask:0xf bank_mask:0xf
    v_add_f32_dpp v240, v240, v240 row_ror:4 row_mask:0xf bank_mask:0xf
    v_add_f32_dpp v239, v239, v239 row_ror:4 row_mask:0xf bank_mask:0xf
    v_add_f32_dpp v246, v246, v246 row_ror:2 row_mask:0xf bank_mask:0xf
    v_add_f32_dpp v245, v245, v245 row_ror:2 row_mask:0xf bank_mask:0xf
    v_add_f32_dpp v244, v244, v244 row_ror:2 row_mask:0xf bank_mask:0xf
    v_add_f32_dpp v243, v243, v243 row_ror:2 row_mask:0xf bank_mask:0xf
    v_add_f32_dpp v242, v242, v242 row_ror:2 row_mask:0xf bank_mask:0xf
    v_add_f32_dpp v241, v241, v241 row_ror:2 row_mask:0xf bank_mask:0xf
    v_add_f32_dpp v240, v240, v240 row_ror:2 row_mask:0xf bank_mask:0xf
    v_add_f32_dpp v239, v239, v239 row_ror:2 row_mask:0xf bank_mask:0xf
    v_add_f32_dpp v246, v246, v246 row_ror:1 row_mask:0xf bank_mask:0xf
    v_add_f32_dpp v245, v245, v245 row_ror:1 row_mask:0xf bank_mask:0xf
    v_add_f32_dpp v244, v244, v244 row_ror:1 row_mask:0xf bank_mask:0xf
    v_add_f32_dpp v243, v243, v243 row_ror:1 row_mask:0xf bank_mask:0xf
    v_add_f32_dpp v242, v242, v242 row_ror:1 row_mask:0xf bank_mask:0xf
    v_add_f32_dpp v241, v241, v241 row_ror:1 row_mask:0xf bank_mask:0xf
    v_add_f32_dpp v240, v240, v240 row_ror:1 row_mask:0xf bank_mask:0xf
    v_add_f32_dpp v239, v239, v239 row_ror:1 row_mask:0xf bank_mask:0xf
    v_and_b32 v252, 3, v254
    v_mov_b32 v238, v246
    v_mov_b32 v237, v242
    v_cmp_eq_u32 vcc, 1, v252
    s_nop 1
    v_cndmask_b32 v238, v238, v245, vcc
    v_cndmask_b32 v237, v237, v241, vcc
    v_cmp_eq_u32 vcc, 2, v252
    s_nop 1
    v_cndmask_b32 v238, v238, v244, vcc
    v_cndmask_b32 v237, v237, v240, vcc
    v_cmp_eq_u32 vcc, 3, v252
    s_nop 1
    v_cndmask_b32 v238, v238, v243, vcc
    v_cndmask_b32 v237, v237, v239, vcc
    v_mul_f32 v68, 0x3b124925, v238
    v_mul_f32 v250, 0x3b124925, v237
    v_fma_f32 v250, -v68, v68, v250
    v_max_f32 v250, 0, v250
    v_add_f32 v249, 0x3727c5ac, v250
    v_rsq_f32 v69, v249
    s_nop 0
    v_mul_f32 v249, v69, v69
    v_mul_f32 v249, v249, v250
    v_add_f32 v249, 0x3727c5ac, v249
    v_rsq_f32 v249, v249
    s_nop 0
    v_mul_f32 v70, v69, v249
    s_waitcnt lgkmcnt(0)
    s_mul_i32 s96, s96, 0x9E3779B1
    s_add_u32 s96, s96, 0x7F4A7C15
    v_mov_b32 v71, s96
    v_lshl_add_u32 v251, v252, 2, v255
    v_lshlrev_b32 v251, 4, v251
    v_cmp_gt_u32 vcc, 4, v254
    v_mov_b32 v250, 33554432
    s_lshl_b32 s84, s80, 4
    s_add_u32 s84, s84, 11010048
    v_cndmask_b32 v251, v250, v251, vcc
    buffer_store_dwordx4 v[68:71], v251, s[28:31], s84 offen sc1
    s_mov_b32 s36, s68
    s_and_b32 s37, s69, 0xffff
    s_mov_b32 s38, 1605632
    s_mov_b32 s39, 0x20000
    s_mov_b32 s16, s54
    s_and_b32 s17, s55, 0xffff
    s_mov_b32 s18, 401408
    s_mov_b32 s19, 0x20000
    s_mov_b32 s20, s56
    s_and_b32 s21, s57, 0xffff
    s_mov_b32 s22, 401408
    s_mov_b32 s23, 0x20000
    s_sub_u32 s80, s2, 224
    s_and_b32 s81, s80, 7
    s_lshr_b32 s80, s80, 3
    s_mul_i32 s47, s81, 7
    s_lshr_b32 s47, s47, 2
    v_lshlrev_b32 v249, 4, v1
    s_mul_i32 s82, s3, 7168
    v_add_u32 v249, s82, v249
    s_mul_i32 s83, s80, 401408
    s_mul_i32 s84, s47, 28672
    s_add_u32 s84, s84, s83
    s_add_u32 s47, s47, 1
    s_cmp_eq_u32 s47, 14
    s_cselect_b32 s47, 0, s47
    buffer_load_dwordx4 v[4:7], v249, s[36:39], s84 offen offset:0
    buffer_load_dwordx4 v[8:11], v249, s[36:39], s84 offen offset:1024
    buffer_load_dwordx4 v[12:15], v249, s[36:39], s84 offen offset:2048
    buffer_load_dwordx4 v[16:19], v249, s[36:39], s84 offen offset:3072
    s_add_u32 s84, s84, 4096
    buffer_load_dwordx4 v[20:23], v249, s[36:39], s84 offen offset:0
    buffer_load_dwordx4 v[24:27], v249, s[36:39], s84 offen offset:1024
    buffer_load_dwordx4 v[28:31], v249, s[36:39], s84 offen offset:2048
    s_mul_i32 s84, s47, 28672
    s_add_u32 s84, s84, s83
    s_add_u32 s47, s47, 1
    s_cmp_eq_u32 s47, 14
    s_cselect_b32 s47, 0, s47
    buffer_load_dwordx4 v[32:35], v249, s[36:39], s84 offen offset:0
    buffer_load_dwordx4 v[36:39], v249, s[36:39], s84 offen offset:1024
    buffer_load_dwordx4 v[40:43], v249, s[36:39], s84 offen offset:2048
    buffer_load_dwordx4 v[44:47], v249, s[36:39], s84 offen offset:3072
    s_add_u32 s84, s84, 4096
    buffer_load_dwordx4 v[48:51], v249, s[36:39], s84 offen offset:0
    s_waitcnt vmcnt(11)
    buffer_load_dwordx4 v[4:7], v249, s[36:39], s84 offen offset:1024
    s_waitcnt vmcnt(11)
    buffer_load_dwordx4 v[8:11], v249, s[36:39], s84 offen offset:2048
    s_mul_i32 s84, s47, 28672
    s_add_u32 s84, s84, s83
    s_add_u32 s47, s47, 1
    s_cmp_eq_u32 s47, 14
    s_cselect_b32 s47, 0, s47
    s_waitcnt vmcnt(11)
    buffer_load_dwordx4 v[12:15], v249, s[36:39], s84 offen offset:0
    s_waitcnt vmcnt(11)
    buffer_load_dwordx4 v[16:19], v249, s[36:39], s84 offen offset:1024
    s_waitcnt vmcnt(11)
    buffer_load_dwordx4 v[20:23], v249, s[36:39], s84 offen offset:2048
    s_waitcnt vmcnt(11)
    buffer_load_dwordx4 v[24:27], v249, s[36:39], s84 offen offset:3072
    s_add_u32 s84, s84, 4096
    s_waitcnt vmcnt(11)
    buffer_load_dwordx4 v[28:31], v249, s[36:39], s84 offen offset:0
    s_waitcnt vmcnt(11)
    buffer_load_dwordx4 v[32:35], v249, s[36:39], s84 offen offset:1024
    s_waitcnt vmcnt(11)
    buffer_load_dwordx4 v[36:39], v249, s[36:39], s84 offen offset:2048
    s_mul_i32 s84, s47, 28672
    s_add_u32 s84, s84, s83
    s_add_u32 s47, s47, 1
    s_cmp_eq_u32 s47, 14
    s_cselect_b32 s47, 0, s47
    s_waitcnt vmcnt(11)
    buffer_load_dwordx4 v[40:43], v249, s[36:39], s84 offen offset:0
    s_waitcnt vmcnt(11)
    buffer_load_dwordx4 v[44:47], v249, s[36:39], s84 offen offset:1024
    s_waitcnt vmcnt(11)
    buffer_load_dwordx4 v[48:51], v249, s[36:39], s84 offen offset:2048
    s_waitcnt vmcnt(11)
    buffer_load_dwordx4 v[4:7], v249, s[36:39], s84 offen offset:3072
    s_add_u32 s84, s84, 4096
    s_waitcnt vmcnt(11)
    buffer_load_dwordx4 v[8:11], v249, s[36:39], s84 offen offset:0
    s_waitcnt vmcnt(11)
    buffer_load_dwordx4 v[12:15], v249, s[36:39], s84 offen offset:1024
    s_waitcnt vmcnt(11)
    buffer_load_dwordx4 v[16:19], v249, s[36:39], s84 offen offset:2048
    s_mul_i32 s84, s47, 28672
    s_add_u32 s84, s84, s83
    s_add_u32 s47, s47, 1
    s_cmp_eq_u32 s47, 14
    s_cselect_b32 s47, 0, s47
    s_waitcnt vmcnt(11)
    buffer_load_dwordx4 v[20:23], v249, s[36:39], s84 offen offset:0
    s_waitcnt vmcnt(11)
    buffer_load_dwordx4 v[24:27], v249, s[36:39], s84 offen offset:1024
    s_waitcnt vmcnt(11)
    buffer_load_dwordx4 v[28:31], v249, s[36:39], s84 offen offset:2048
    s_waitcnt vmcnt(11)
    buffer_load_dwordx4 v[32:35], v249, s[36:39], s84 offen offset:3072
    s_add_u32 s84, s84, 4096
    s_waitcnt vmcnt(11)
    buffer_load_dwordx4 v[36:39], v249, s[36:39], s84 offen offset:0
    s_waitcnt vmcnt(11)
    buffer_load_dwordx4 v[40:43], v249, s[36:39], s84 offen offset:1024
    s_waitcnt vmcnt(11)
    buffer_load_dwordx4 v[44:47], v249, s[36:39], s84 offen offset:2048
    s_mul_i32 s84, s47, 28672
    s_add_u32 s84, s84, s83
    s_add_u32 s47, s47, 1
    s_cmp_eq_u32 s47, 14
    s_cselect_b32 s47, 0, s47
    s_waitcnt vmcnt(11)
    buffer_load_dwordx4 v[48:51], v249, s[36:39], s84 offen offset:0
    s_waitcnt vmcnt(11)
    buffer_load_dwordx4 v[4:7], v249, s[36:39], s84 offen offset:1024
    s_waitcnt vmcnt(11)
    buffer_load_dwordx4 v[8:11], v249, s[36:39], s84 offen offset:2048
    s_waitcnt vmcnt(11)
    buffer_load_dwordx4 v[12:15], v249, s[36:39], s84 offen offset:3072
    s_add_u32 s84, s84, 4096
    s_waitcnt vmcnt(11)
    buffer_load_dwordx4 v[16:19], v249, s[36:39], s84 offen offset:0
    s_waitcnt vmcnt(11)
    buffer_load_dwordx4 v[20:23], v249, s[36:39], s84 offen offset:1024
    s_waitcnt vmcnt(11)
    buffer_load_dwordx4 v[24:27], v249, s[36:39], s84 offen offset:2048
    s_mul_i32 s84, s47, 28672
    s_add_u32 s84, s84, s83
    s_add_u32 s47, s47, 1
    s_cmp_eq_u32 s47, 14
    s_cselect_b32 s47, 0, s47
    s_waitcnt vmcnt(11)
    buffer_load_dwordx4 v[28:31], v249, s[36:39], s84 offen offset:0
    s_waitcnt vmcnt(11)
    buffer_load_dwordx4 v[32:35], v249, s[36:39], s84 offen offset:1024
    s_waitcnt vmcnt(11)
    buffer_load_dwordx4 v[36:39], v249, s[36:39], s84 offen offset:2048
    s_waitcnt vmcnt(11)
    buffer_load_dwordx4 v[40:43], v249, s[36:39], s84 offen offset:3072
    s_add_u32 s84, s84, 4096
    s_waitcnt vmcnt(11)
    buffer_load_dwordx4 v[44:47], v249, s[36:39], s84 offen offset:0
    s_waitcnt vmcnt(11)
    buffer_load_dwordx4 v[48:51], v249, s[36:39], s84 offen offset:1024
    s_waitcnt vmcnt(11)
    buffer_load_dwordx4 v[4:7], v249, s[36:39], s84 offen offset:2048
    s_mul_i32 s84, s47, 28672
    s_add_u32 s84, s84, s83
    s_add_u32 s47, s47, 1
    s_cmp_eq_u32 s47, 14
    s_cselect_b32 s47, 0, s47
    s_waitcnt vmcnt(11)
    buffer_load_dwordx4 v[8:11], v249, s[36:39], s84 offen offset:0
    s_waitcnt vmcnt(11)
    buffer_load_dwordx4 v[12:15], v249, s[36:39], s84 offen offset:1024
    s_waitcnt vmcnt(11)
    buffer_load_dwordx4 v[16:19], v249, s[36:39], s84 offen offset:2048
    s_waitcnt vmcnt(11)
    buffer_load_dwordx4 v[20:23], v249, s[36:39], s84 offen offset:3072
    s_add_u32 s84, s84, 4096
    s_waitcnt vmcnt(11)
    buffer_load_dwordx4 v[24:27], v249, s[36:39], s84 offen offset:0
    s_waitcnt vmcnt(11)
    buffer_load_dwordx4 v[28:31], v249, s[36:39], s84 offen offset:1024
    s_waitcnt vmcnt(11)
    buffer_load_dwordx4 v[32:35], v249, s[36:39], s84 offen offset:2048
    s_mul_i32 s84, s47, 28672
    s_add_u32 s84, s84, s83
    s_add_u32 s47, s47, 1
    s_cmp_eq_u32 s47, 14
    s_cselect_b32 s47, 0, s47
    s_waitcnt vmcnt(11)
    buffer_load_dwordx4 v[36:39], v249, s[36:39], s84 offen offset:0
    s_waitcnt vmcnt(11)
    buffer_load_dwordx4 v[40:43], v249, s[36:39], s84 offen offset:1024
    s_waitcnt vmcnt(11)
    buffer_load_dwordx4 v[44:47], v249, s[36:39], s84 offen offset:2048
    s_waitcnt vmcnt(11)
    buffer_load_dwordx4 v[48:51], v249, s[36:39], s84 offen offset:3072
    s_add_u32 s84, s84, 4096
    s_waitcnt vmcnt(11)
    buffer_load_dwordx4 v[4:7], v249, s[36:39], s84 offen offset:0
    s_waitcnt vmcnt(11)
    buffer_load_dwordx4 v[8:11], v249, s[36:39], s84 offen offset:1024
    s_waitcnt vmcnt(11)
    buffer_load_dwordx4 v[12:15], v249, s[36:39], s84 offen offset:2048
    s_mul_i32 s84, s47, 28672
    s_add_u32 s84, s84, s83
    s_add_u32 s47, s47, 1
    s_cmp_eq_u32 s47, 14
    s_cselect_b32 s47, 0, s47
    s_waitcnt vmcnt(11)
    buffer_load_dwordx4 v[16:19], v249, s[36:39], s84 offen offset:0
    s_waitcnt vmcnt(11)
    buffer_load_dwordx4 v[20:23], v249, s[36:39], s84 offen offset:1024
    s_waitcnt vmcnt(11)
    buffer_load_dwordx4 v[24:27], v249, s[36:39], s84 offen offset:2048
    s_waitcnt vmcnt(11)
    buffer_load_dwordx4 v[28:31], v249, s[36:39], s84 offen offset:3072
    s_add_u32 s84, s84, 4096
    s_waitcnt vmcnt(11)
    buffer_load_dwordx4 v[32:35], v249, s[36:39], s84 offen offset:0
    s_waitcnt vmcnt(11)
    buffer_load_dwordx4 v[36:39], v249, s[36:39], s84 offen offset:1024
    s_waitcnt vmcnt(11)
    buffer_load_dwordx4 v[40:43], v249, s[36:39], s84 offen offset:2048
    s_mul_i32 s84, s47, 28672
    s_add_u32 s84, s84, s83
    s_add_u32 s47, s47, 1
    s_cmp_eq_u32 s47, 14
    s_cselect_b32 s47, 0, s47
    s_waitcnt vmcnt(11)
    buffer_load_dwordx4 v[44:47], v249, s[36:39], s84 offen offset:0
    s_waitcnt vmcnt(11)
    buffer_load_dwordx4 v[48:51], v249, s[36:39], s84 offen offset:1024
    s_waitcnt vmcnt(11)
    buffer_load_dwordx4 v[4:7], v249, s[36:39], s84 offen offset:2048
    s_waitcnt vmcnt(11)
    buffer_load_dwordx4 v[8:11], v249, s[36:39], s84 offen offset:3072
    s_add_u32 s84, s84, 4096
    s_waitcnt vmcnt(11)
    buffer_load_dwordx4 v[12:15], v249, s[36:39], s84 offen offset:0
    s_waitcnt vmcnt(11)
    buffer_load_dwordx4 v[16:19], v249, s[36:39], s84 offen offset:1024
    s_waitcnt vmcnt(11)
    buffer_load_dwordx4 v[20:23], v249, s[36:39], s84 offen offset:2048
    s_mul_i32 s84, s47, 28672
    s_add_u32 s84, s84, s83
    s_add_u32 s47, s47, 1
    s_cmp_eq_u32 s47, 14
    s_cselect_b32 s47, 0, s47
    s_waitcnt vmcnt(11)
    buffer_load_dwordx4 v[24:27], v249, s[36:39], s84 offen offset:0
    s_waitcnt vmcnt(11)
    buffer_load_dwordx4 v[28:31], v249, s[36:39], s84 offen offset:1024
    s_waitcnt vmcnt(11)
    buffer_load_dwordx4 v[32:35], v249, s[36:39], s84 offen offset:2048
    s_waitcnt vmcnt(11)
    buffer_load_dwordx4 v[36:39], v249, s[36:39], s84 offen offset:3072
    s_add_u32 s84, s84, 4096
    s_waitcnt vmcnt(11)
    buffer_load_dwordx4 v[40:43], v249, s[36:39], s84 offen offset:0
    s_waitcnt vmcnt(11)
    buffer_load_dwordx4 v[44:47], v249, s[36:39], s84 offen offset:1024
    s_waitcnt vmcnt(11)
    buffer_load_dwordx4 v[48:51], v249, s[36:39], s84 offen offset:2048
    s_mul_i32 s84, s47, 28672
    s_add_u32 s84, s84, s83
    s_add_u32 s47, s47, 1
    s_cmp_eq_u32 s47, 14
    s_cselect_b32 s47, 0, s47
    s_waitcnt vmcnt(11)
    buffer_load_dwordx4 v[4:7], v249, s[36:39], s84 offen offset:0
    s_waitcnt vmcnt(11)
    buffer_load_dwordx4 v[8:11], v249, s[36:39], s84 offen offset:1024
    s_waitcnt vmcnt(11)
    buffer_load_dwordx4 v[12:15], v249, s[36:39], s84 offen offset:2048
    s_waitcnt vmcnt(11)
    buffer_load_dwordx4 v[16:19], v249, s[36:39], s84 offen offset:3072
    s_add_u32 s84, s84, 4096
    s_waitcnt vmcnt(11)
    buffer_load_dwordx4 v[20:23], v249, s[36:39], s84 offen offset:0
    s_waitcnt vmcnt(11)
    buffer_load_dwordx4 v[24:27], v249, s[36:39], s84 offen offset:1024
    s_waitcnt vmcnt(11)
    buffer_load_dwordx4 v[28:31], v249, s[36:39], s84 offen offset:2048
    s_mul_i32 s84, s47, 28672
    s_add_u32 s84, s84, s83
    s_add_u32 s47, s47, 1
    s_cmp_eq_u32 s47, 14
    s_cselect_b32 s47, 0, s47
    s_waitcnt vmcnt(11)
    buffer_load_dwordx4 v[32:35], v249, s[36:39], s84 offen offset:0
    s_waitcnt vmcnt(11)
    buffer_load_dwordx4 v[36:39], v249, s[36:39], s84 offen offset:1024
    s_waitcnt vmcnt(11)
    buffer_load_dwordx4 v[40:43], v249, s[36:39], s84 offen offset:2048
    s_waitcnt vmcnt(11)
    buffer_load_dwordx4 v[44:47], v249, s[36:39], s84 offen offset:3072
    s_add_u32 s84, s84, 4096
    s_waitcnt vmcnt(11)
    buffer_load_dwordx4 v[48:51], v249, s[36:39], s84 offen offset:0
    s_waitcnt vmcnt(11)
    buffer_load_dwordx4 v[4:7], v249, s[36:39], s84 offen offset:1024
    s_waitcnt vmcnt(11)
    buffer_load_dwordx4 v[8:11], v249, s[36:39], s84 offen offset:2048
    v_lshlrev_b32 v249, 4, v1
    s_mul_i32 s82, s3, 25600
    v_add_u32 v249, s82, v249
    s_mul_i32 s84, s80, 100352
    s_waitcnt vmcnt(11)
    buffer_load_dwordx4 v[12:15], v249, s[16:19], s84 offen offset:0
    s_waitcnt vmcnt(11)
    buffer_load_dwordx4 v[16:19], v249, s[20:23], s84 offen offset:0
    s_waitcnt vmcnt(11)
    buffer_load_dwordx4 v[20:23], v249, s[16:19], s84 offen offset:1024
    s_waitcnt vmcnt(11)
    buffer_load_dwordx4 v[24:27], v249, s[20:23], s84 offen offset:1024
    s_waitcnt vmcnt(11)
    buffer_load_dwordx4 v[28:31], v249, s[16:19], s84 offen offset:2048
    s_waitcnt vmcnt(11)
    buffer_load_dwordx4 v[32:35], v249, s[20:23], s84 offen offset:2048
    s_waitcnt vmcnt(11)
    buffer_load_dwordx4 v[36:39], v249, s[16:19], s84 offen offset:3072
    s_waitcnt vmcnt(11)
    buffer_load_dwordx4 v[40:43], v249, s[20:23], s84 offen offset:3072
    s_add_u32 s84, s84, 4096
    s_waitcnt vmcnt(11)
    buffer_load_dwordx4 v[44:47], v249, s[16:19], s84 offen offset:0
    s_waitcnt vmcnt(11)
    buffer_load_dwordx4 v[48:51], v249, s[20:23], s84 offen offset:0
    s_waitcnt vmcnt(11)
    buffer_load_dwordx4 v[4:7], v249, s[16:19], s84 offen offset:1024
    s_waitcnt vmcnt(11)
    buffer_load_dwordx4 v[8:11], v249, s[20:23], s84 offen offset:1024
    s_waitcnt vmcnt(11)
    buffer_load_dwordx4 v[12:15], v249, s[16:19], s84 offen offset:2048
    s_waitcnt vmcnt(11)
    buffer_load_dwordx4 v[16:19], v249, s[20:23], s84 offen offset:2048
    s_waitcnt vmcnt(11)
    buffer_load_dwordx4 v[20:23], v249, s[16:19], s84 offen offset:3072
    s_waitcnt vmcnt(11)
    buffer_load_dwordx4 v[24:27], v249, s[20:23], s84 offen offset:3072
    s_add_u32 s84, s84, 4096
    s_waitcnt vmcnt(11)
    buffer_load_dwordx4 v[28:31], v249, s[16:19], s84 offen offset:0
    s_waitcnt vmcnt(11)
    buffer_load_dwordx4 v[32:35], v249, s[20:23], s84 offen offset:0
    s_waitcnt vmcnt(11)
    buffer_load_dwordx4 v[36:39], v249, s[16:19], s84 offen offset:1024
    s_waitcnt vmcnt(11)
    buffer_load_dwordx4 v[40:43], v249, s[20:23], s84 offen offset:1024
    s_waitcnt vmcnt(11)
    buffer_load_dwordx4 v[44:47], v249, s[16:19], s84 offen offset:2048
    s_waitcnt vmcnt(11)
    buffer_load_dwordx4 v[48:51], v249, s[20:23], s84 offen offset:2048
    s_waitcnt vmcnt(11)
    buffer_load_dwordx4 v[4:7], v249, s[16:19], s84 offen offset:3072
    s_waitcnt vmcnt(11)
    buffer_load_dwordx4 v[8:11], v249, s[20:23], s84 offen offset:3072
    s_add_u32 s84, s84, 4096
    s_waitcnt vmcnt(11)
    buffer_load_dwordx4 v[12:15], v249, s[16:19], s84 offen offset:0
    s_waitcnt vmcnt(11)
    buffer_load_dwordx4 v[16:19], v249, s[20:23], s84 offen offset:0
    s_waitcnt vmcnt(11)
    buffer_load_dwordx4 v[20:23], v249, s[16:19], s84 offen offset:1024
    s_waitcnt vmcnt(11)
    buffer_load_dwordx4 v[24:27], v249, s[20:23], s84 offen offset:1024
    s_waitcnt vmcnt(11)
    buffer_load_dwordx4 v[28:31], v249, s[16:19], s84 offen offset:2048
    s_waitcnt vmcnt(11)
    buffer_load_dwordx4 v[32:35], v249, s[20:23], s84 offen offset:2048
    s_waitcnt vmcnt(11)
    buffer_load_dwordx4 v[36:39], v249, s[16:19], s84 offen offset:3072
    s_waitcnt vmcnt(11)
    buffer_load_dwordx4 v[40:43], v249, s[20:23], s84 offen offset:3072
    s_add_u32 s84, s84, 4096
    s_waitcnt vmcnt(11)
    buffer_load_dwordx4 v[44:47], v249, s[16:19], s84 offen offset:0
    s_waitcnt vmcnt(11)
    buffer_load_dwordx4 v[48:51], v249, s[20:23], s84 offen offset:0
    s_waitcnt vmcnt(11)
    buffer_load_dwordx4 v[4:7], v249, s[16:19], s84 offen offset:1024
    s_waitcnt vmcnt(11)
    buffer_load_dwordx4 v[8:11], v249, s[20:23], s84 offen offset:1024
    s_waitcnt vmcnt(11)
    buffer_load_dwordx4 v[12:15], v249, s[16:19], s84 offen offset:2048
    s_waitcnt vmcnt(11)
    buffer_load_dwordx4 v[16:19], v249, s[20:23], s84 offen offset:2048
    s_waitcnt vmcnt(11)
    buffer_load_dwordx4 v[20:23], v249, s[16:19], s84 offen offset:3072
    s_waitcnt vmcnt(11)
    buffer_load_dwordx4 v[24:27], v249, s[20:23], s84 offen offset:3072
    s_add_u32 s84, s84, 4096
    s_waitcnt vmcnt(11)
    buffer_load_dwordx4 v[28:31], v249, s[16:19], s84 offen offset:0
    s_waitcnt vmcnt(11)
    buffer_load_dwordx4 v[32:35], v249, s[20:23], s84 offen offset:0
    s_waitcnt vmcnt(11)
    buffer_load_dwordx4 v[36:39], v249, s[16:19], s84 offen offset:1024
    s_waitcnt vmcnt(11)
    buffer_load_dwordx4 v[40:43], v249, s[20:23], s84 offen offset:1024
    s_waitcnt vmcnt(11)
    buffer_load_dwordx4 v[44:47], v249, s[16:19], s84 offen offset:2048
    s_waitcnt vmcnt(11)
    buffer_load_dwordx4 v[48:51], v249, s[20:23], s84 offen offset:2048
    s_waitcnt vmcnt(11)
    buffer_load_dwordx4 v[4:7], v249, s[16:19], s84 offen offset:3072
    s_waitcnt vmcnt(11)
    buffer_load_dwordx4 v[8:11], v249, s[20:23], s84 offen offset:3072
    s_add_u32 s84, s84, 4096
    s_waitcnt vmcnt(11)
    buffer_load_dwordx4 v[12:15], v249, s[16:19], s84 offen offset:0
    s_waitcnt vmcnt(11)
    buffer_load_dwordx4 v[16:19], v249, s[20:23], s84 offen offset:0
    s_waitcnt vmcnt(0)
    s_endpgm
L_endcode:
    s_endpgm
.section .rodata,"a"
.p2align 6
.amdhsa_kernel recurrent_scan__ssm_conv_s5__mixer_channel_mlp__prompt_kernel
  .amdhsa_next_free_vgpr 512
  .amdhsa_next_free_sgpr 102
  .amdhsa_accum_offset 256
  .amdhsa_group_segment_fixed_size 0
  .amdhsa_kernarg_size 136
  .amdhsa_user_sgpr_count 2
  .amdhsa_user_sgpr_kernarg_segment_ptr 1
  .amdhsa_system_sgpr_workgroup_id_x 1
.end_amdhsa_kernel
```
